```python
import torch

def _softmax(x, axis=-1):
    return torch.softmax(x, dim=axis)
def _gelu(x):
    return torch.nn.functional.gelu(x, approximate="tanh")
def _silu(x):
    return torch.nn.functional.silu(x)
def _sigmoid(x):
    return torch.sigmoid(x)
def _layernorm(x, axis=-1, eps=1e-5):
    m = x.mean(dim=axis, keepdim=True)
    v = x.var(dim=axis, keepdim=True, unbiased=False)
    return (x - m) / torch.sqrt(v + eps)
def _scatter_add(tgt, idx, src, axis=0):
    return tgt.clone().index_add_(axis, idx, src)
def _segment_sum(src, seg, n):
    out = torch.zeros((n,) + src.shape[1:], dtype=src.dtype)
    return out.index_add_(0, seg, src)
def _pad(x, pw):
    flat = tuple(v for pair in reversed(pw) for v in pair)
    return torch.nn.functional.pad(x, flat)

kernel_name = 'gated_mix__ssm_conv_s4__dense_activation_relu__prompt'

def setup_inputs():

    _w = (lambda a: (lambda t: t.to(torch.bfloat16) if t.is_floating_point() else t)(torch.as_tensor(a)))
    def _A_setup():
        B, L, D, N = 1, 2048, 512, 128
        A_re = -(lambda _x: torch.exp(torch.as_tensor(_x)))((lambda *s: torch.randn(*s, dtype=torch.bfloat16) * 3.2)(D, N))
        A_im = torch.pi * (lambda *s: torch.randn(*s, dtype=torch.bfloat16) * 0.1)(D, N)
        B_re = (lambda *s: torch.randn(*s, dtype=torch.bfloat16) * 0.4)(D, N)
        B_im = (lambda *s: torch.randn(*s, dtype=torch.bfloat16) * 0.4)(D, N)
        C_re = (lambda *s: torch.randn(*s, dtype=torch.bfloat16) * 0.4)(D, N)
        C_im = (lambda *s: torch.randn(*s, dtype=torch.bfloat16) * 0.4)(D, N)
        log_dt = (lambda *s: torch.randn(*s, dtype=torch.bfloat16) * 0.1)(D) * 0.5 - 4.0
        Dskip = (lambda *s: torch.randn(*s, dtype=torch.bfloat16) * 0.2)(D)
        return {
            "u": _w((lambda *s: torch.randn(*s, dtype=torch.bfloat16) * 0.05)(B, L, D)),
            "A_re": _w(A_re),
            "A_im": _w(A_im),
            "B_re": _w(B_re),
            "B_im": _w(B_im),
            "C_re": _w(C_re),
            "C_im": _w(C_im),
            "log_dt": _w(log_dt),
            "Dskip": _w(Dskip),
        }
    _A_in = _A_setup()

    def _B_setup():
        B, S, D, Dff = 1, 2048, 512, 1376
        return {
            "x": _w((lambda *s: torch.randn(*s, dtype=torch.bfloat16) * 0.05)(B, S, D)),
            "w1": _w((lambda *s: torch.randn(*s, dtype=torch.bfloat16) * 0.05)(D, Dff)),
            "w2": _w((lambda *s: torch.randn(*s, dtype=torch.bfloat16) * 0.05)(Dff, D)),
        }
    _B_in = _B_setup()

    return {
        "A_u": _A_in["u"],
        "A_A_re": _A_in["A_re"],
        "A_A_im": _A_in["A_im"],
        "A_B_re": _A_in["B_re"],
        "A_B_im": _A_in["B_im"],
        "A_C_re": _A_in["C_re"],
        "A_C_im": _A_in["C_im"],
        "A_log_dt": _A_in["log_dt"],
        "A_Dskip": _A_in["Dskip"],
        "B_x": _B_in["x"],
        "B_w1": _B_in["w1"],
        "B_w2": _B_in["w2"],
        "gate_w": _w((lambda *s: torch.randn(*s, dtype=torch.bfloat16) * 0.05)(512) * 16.0),
    }

def reference(A_u, A_A_re, A_A_im, A_B_re, A_B_im, A_C_re, A_C_im, A_log_dt, A_Dskip, B_x, B_w1, B_w2, gate_w):
    def _A_ref(u, A_re, A_im, B_re, B_im, C_re, C_im, log_dt, Dskip):
        Bsz, L, D = u.shape
        dt = torch.exp(log_dt)[:, None]
        A = A_re + 1j * A_im
        Bc = B_re + 1j * B_im
        Cc = C_re + 1j * C_im
        logdA = dt * A
        dB = dt * Bc
        l = (lambda x, dt: x.to(dt))(torch.arange(L), A_re.dtype)
        P = torch.exp(logdA[:, :, None] * l[None, None, :])
        K = torch.einsum("dn,dnl,dn->dl", Cc, P, dB).real
        L2 = 2 * L
        Kp = _pad(K, ((0, 0), (0, L)))
        up = (lambda x, *d: x.permute(*d))(u, 0, 2, 1)
        up = _pad(up, ((0, 0), (0, 0), (0, L)))
        Kf = (lambda x, axes=(-2,-1): torch.fft.rfft2(x.float(), dim=axes))(Kp[:, None, :], axes=(-2, -1))
        Uf = (lambda x, axes=(-2,-1): torch.fft.rfft2(x.float(), dim=axes))(up[:, :, None, :], axes=(-2, -1))
        Yf = Uf * Kf[None, :, :, :]
        y = (lambda x, s, axes=(-2,-1): torch.fft.irfft2(x, s=s, dim=axes).to(torch.bfloat16))(Yf, (1, L2), axes=(-2, -1))[:, :, 0, :L]
        y = (lambda x, *d: x.permute(*d))(y, 0, 2, 1) + u * Dskip[None, None, :]
        return y

    def _B_ref(x, w1, w2):
        h = torch.einsum("bsd,df->bsf", x, w1)
        zero = torch.zeros_like(h)
        h = torch.maximum(h, zero)
        return torch.einsum("bsf,fd->bsd", h, w2)

    x = A_u
    g = _sigmoid((x * gate_w).sum(-1, keepdims=True))
    a = _A_ref(x, A_A_re, A_A_im, A_B_re, A_B_im, A_C_re, A_C_im, A_log_dt, A_Dskip)
    b = _B_ref(x, B_w1, B_w2)
    return g * a + (1 - g) * b
```

```asm
; @launch grid=(512,1,1) block=(256,1,1) lds=81920
.amdgcn_target "amdgcn-amd-amdhsa--gfx950"

.text
.globl gated_mix__ssm_conv_s4__dense_activation_relu__prompt_kernel
.p2align 8
.type gated_mix__ssm_conv_s4__dense_activation_relu__prompt_kernel,@function
gated_mix__ssm_conv_s4__dense_activation_relu__prompt_kernel:
    s_cmp_ge_u32 s2, 512
    s_cbranch_scc1 END_ALL
    s_xor_b32 s2, s2, 256
    s_cmp_ge_u32 s2, 256
    s_cbranch_scc1 SSM_ROLE
    s_load_dwordx2 s[12:13], s[0:1], 0
    s_load_dwordx8 s[4:11], s[0:1], 80
    s_load_dwordx2 s[14:15], s[0:1], 120
    v_lshrrev_b32 v1, 6, v0
    v_and_b32 v0, 63, v0
    s_and_b32 s58, s2, 7
    s_lshr_b32 s59, s2, 3
    v_readfirstlane_b32 s52, v1
    s_lshr_b32 s53, s58, 1
    s_lshl_b32 s53, s53, 2
    s_and_b32 s60, s59, 3
    s_add_u32 s53, s53, s60
    s_and_b32 s54, s58, 1
    s_lshl_b32 s54, s54, 3
    s_lshr_b32 s60, s59, 2
    s_add_u32 s54, s54, s60
    s_and_b32 s60, s54, 1
    s_lshl_b32 s55, s53, 1
    s_add_u32 s55, s55, s60
    s_lshr_b32 s56, s54, 1
    s_lshl_b32 s60, s54, 1
    s_mul_i32 s61, s54, 3
    s_sub_i32 s61, s61, 5
    s_max_i32 s57, s60, s61
    v_lshrrev_b32 v26, 3, v0
    v_and_b32 v27, 7, v0
    v_lshrrev_b32 v28, 4, v0
    v_xor_b32 v27, v27, v28
    v_lshlrev_b32 v27, 4, v27
    v_lshl_add_u32 v16, v26, 10, v27
    v_xor_b32 v17, 64, v16
    v_lshlrev_b32 v6, 4, v0
    s_mul_i32 s58, s52, 192
    v_add_u32 v26, s58, v0
    v_add_u32 v26, 0, v26
    v_mul_u32_u24 v27, 0xaaab, v26
    v_lshrrev_b32 v27, 19, v27
    v_mul_u32_u24 v28, 12, v27
    v_sub_u32 v28, v26, v28
    v_lshrrev_b32 v29, 3, v27
    v_and_b32 v29, 1, v29
    v_lshlrev_b32 v29, 1, v29
    v_xor_b32 v28, v28, v29
    v_lshlrev_b32 v28, 4, v28
    v_mul_u32_u24 v27, 2752, v27
    v_add_u32 v18, v27, v28
    v_add_u32 v26, s58, v0
    v_add_u32 v26, 64, v26
    v_mul_u32_u24 v27, 0xaaab, v26
    v_lshrrev_b32 v27, 19, v27
    v_mul_u32_u24 v28, 12, v27
    v_sub_u32 v28, v26, v28
    v_lshrrev_b32 v29, 3, v27
    v_and_b32 v29, 1, v29
    v_lshlrev_b32 v29, 1, v29
    v_xor_b32 v28, v28, v29
    v_lshlrev_b32 v28, 4, v28
    v_mul_u32_u24 v27, 2752, v27
    v_add_u32 v19, v27, v28
    v_add_u32 v26, s58, v0
    v_add_u32 v26, 128, v26
    v_mul_u32_u24 v27, 0xaaab, v26
    v_lshrrev_b32 v27, 19, v27
    v_mul_u32_u24 v28, 12, v27
    v_sub_u32 v28, v26, v28
    v_lshrrev_b32 v29, 3, v27
    v_and_b32 v29, 1, v29
    v_lshlrev_b32 v29, 1, v29
    v_xor_b32 v28, v28, v29
    v_lshlrev_b32 v28, 4, v28
    v_mul_u32_u24 v27, 2752, v27
    v_add_u32 v20, v27, v28
    s_waitcnt lgkmcnt(0)
    s_lshl_b32 s58, s53, 17
    s_lshl_b32 s59, s52, 15
    s_add_u32 s58, s58, s59
    s_add_u32 s16, s12, s58
    s_addc_u32 s17, s13, 0
    s_mov_b32 s18, 0x8000
    s_mov_b32 s19, 0x20000
    s_lshl_b32 s58, s57, 6
    s_add_u32 s20, s4, s58
    s_addc_u32 s21, s5, 0
    s_mov_b32 s22, 0
    s_mov_b32 s23, 0x20000
    s_sub_u32 s22, 1409024, s58
    s_mov_b32 s24, s8
    s_mov_b32 s25, s9
    s_mov_b32 s26, 1024
    s_mov_b32 s27, 0x20000
    s_mul_i32 s64, s52, 3072
    s_add_u32 s64, s64, 8192
    s_mul_i32 s67, s52, 20480
    s_mov_b32 s58, 0
    s_add_u32 m0, s67, 0
    s_nop 0
    buffer_load_dwordx4 v16, s[16:19], s58 offen lds
    s_mov_b32 s58, 8192
    s_add_u32 m0, s67, 1024
    s_nop 0
    buffer_load_dwordx4 v17, s[16:19], s58 offen lds
    s_mov_b32 s58, 16384
    s_add_u32 m0, s67, 2048
    s_nop 0
    buffer_load_dwordx4 v16, s[16:19], s58 offen lds
    s_mov_b32 s58, 24576
    s_add_u32 m0, s67, 3072
    s_nop 0
    buffer_load_dwordx4 v17, s[16:19], s58 offen lds
    s_mov_b32 s59, 0
    s_add_u32 m0, s64, 0
    s_nop 0
    buffer_load_dwordx4 v18, s[20:23], s59 offen lds
    s_add_u32 m0, s64, 1024
    s_nop 0
    buffer_load_dwordx4 v19, s[20:23], s59 offen lds
    s_add_u32 m0, s64, 2048
    s_nop 0
    buffer_load_dwordx4 v20, s[20:23], s59 offen lds
    s_mov_b32 m0, 69632
    s_nop 0
    buffer_load_dwordx4 v6, s[24:27], 0 offen lds
    s_mov_b32 s58, 128
    s_add_u32 m0, s67, 4096
    s_nop 0
    buffer_load_dwordx4 v16, s[16:19], s58 offen lds
    s_mov_b32 s58, 8320
    s_add_u32 m0, s67, 5120
    s_nop 0
    buffer_load_dwordx4 v17, s[16:19], s58 offen lds
    s_mov_b32 s58, 16512
    s_add_u32 m0, s67, 6144
    s_nop 0
    buffer_load_dwordx4 v16, s[16:19], s58 offen lds
    s_mov_b32 s58, 24704
    s_add_u32 m0, s67, 7168
    s_nop 0
    buffer_load_dwordx4 v17, s[16:19], s58 offen lds
    s_mov_b32 s59, 176128
    s_add_u32 m0, s64, 20480
    s_nop 0
    buffer_load_dwordx4 v18, s[20:23], s59 offen lds
    s_add_u32 m0, s64, 21504
    s_nop 0
    buffer_load_dwordx4 v19, s[20:23], s59 offen lds
    s_add_u32 m0, s64, 22528
    s_nop 0
    buffer_load_dwordx4 v20, s[20:23], s59 offen lds
    s_add_u32 s60, s14, 10551296
    s_addc_u32 s61, s15, 0
    s_load_dword s63, s[60:61], 0
    s_add_u32 s48, s14, 10551296
    s_addc_u32 s49, s15, 0
    s_mov_b32 s50, 0x100000
    s_mov_b32 s51, 0x20000
    v_lshrrev_b32 v12, 3, v0
    v_lshlrev_b32 v12, 10, v12
    v_lshrrev_b32 v13, 4, v0
    v_bfe_u32 v14, v0, 1, 2
    v_xor_b32 v14, v14, v13
    v_and_b32 v15, 1, v0
    v_lshlrev_b32 v14, 5, v14
    v_lshl_add_u32 v14, v15, 4, v14
    v_add_u32 v1, v12, v14
    s_mul_i32 s66, s52, 11
    s_cmp_eq_u32 s52, 3
    s_cselect_b32 s66, 32, s66
    s_mul_i32 s67, s52, 20480
    s_lshl_b32 s58, s56, 7
    s_add_u32 s32, s6, s58
    s_addc_u32 s33, s7, 0
    s_mov_b32 s34, 0
    s_mov_b32 s35, 0x20000
    s_sub_u32 s34, 1409024, s58
    v_lshrrev_b32 v12, 4, v0
    v_bfe_u32 v13, v0, 2, 2
    v_lshl_add_u32 v13, v12, 3, v13
    v_mul_u32_u24 v13, 192, v13
    v_and_b32 v14, 3, v0
    v_lshl_add_u32 v13, v14, 3, v13
    v_add_u32 v13, 8192, v13
    v_and_b32 v14, 1, v12
    v_lshlrev_b32 v14, 5, v14
    v_add_u32 v21, v13, v14
    v_sub_u32 v22, v13, v14
    v_lshlrev_b32 v23, 4, v12
    v_add_u32 v23, 69632, v23
    v_and_b32 v13, 15, v0
    v_bfe_u32 v14, v0, 1, 3
    v_xor_b32 v14, v14, v12
    v_lshlrev_b32 v14, 4, v14
    v_lshl_add_u32 v14, v13, 7, v14
    v_add_u32 v24, s67, v14
    v_xor_b32 v25, 64, v24
    s_lshr_b32 s60, s52, 1
    s_and_b32 s61, s54, 1
    s_xor_b32 s65, s60, s61
    s_waitcnt vmcnt(7)
    s_barrier
    s_setprio 2
    ds_read_b128 v[124:127], v24 offset:0
    ds_read_b128 v[128:131], v24 offset:2048
    ds_read_b128 v[132:135], v25 offset:0
    ds_read_b128 v[136:139], v25 offset:2048
    ds_read_b64_tr_b16 v[76:77], v21 offset:0
    ds_read_b64_tr_b16 v[78:79], v21 offset:768
    ds_read_b64_tr_b16 v[80:81], v22 offset:32
    ds_read_b64_tr_b16 v[82:83], v22 offset:800
    ds_read_b64_tr_b16 v[84:85], v21 offset:64
    ds_read_b64_tr_b16 v[86:87], v21 offset:832
    ds_read_b64_tr_b16 v[88:89], v22 offset:96
    ds_read_b64_tr_b16 v[90:91], v22 offset:864
    ds_read_b64_tr_b16 v[92:93], v21 offset:128
    ds_read_b64_tr_b16 v[94:95], v21 offset:896
    ds_read_b64_tr_b16 v[96:97], v22 offset:160
    ds_read_b64_tr_b16 v[98:99], v22 offset:928
    ds_read_b128 v[156:159], v23 offset:0
    s_waitcnt lgkmcnt(0)
    v_mfma_f32_16x16x32_bf16 v[172:175], v[76:79], v[124:127], 0
    ds_read_b64_tr_b16 v[100:101], v21 offset:6144
    ds_read_b64_tr_b16 v[102:103], v21 offset:6912
    v_mfma_f32_16x16x32_bf16 v[196:199], v[76:79], v[128:131], 0
    ds_read_b64_tr_b16 v[104:105], v22 offset:6176
    ds_read_b64_tr_b16 v[106:107], v22 offset:6944
    s_mov_b32 s59, 352256
    s_add_u32 m0, s64, 40960
    s_nop 0
    buffer_load_dwordx4 v18, s[20:23], s59 offen lds
    v_mfma_f32_16x16x32_bf16 v[176:179], v[80:83], v[124:127], 0
    ds_read_b64_tr_b16 v[108:109], v21 offset:6208
    ds_read_b64_tr_b16 v[110:111], v21 offset:6976
    v_mfma_f32_16x16x32_bf16 v[200:203], v[80:83], v[128:131], 0
    ds_read_b64_tr_b16 v[112:113], v22 offset:6240
    ds_read_b64_tr_b16 v[114:115], v22 offset:7008
    s_add_u32 m0, s64, 41984
    s_nop 0
    buffer_load_dwordx4 v19, s[20:23], s59 offen lds
    v_mfma_f32_16x16x32_bf16 v[180:183], v[84:87], v[124:127], 0
    ds_read_b64_tr_b16 v[116:117], v21 offset:6272
    ds_read_b64_tr_b16 v[118:119], v21 offset:7040
    v_mfma_f32_16x16x32_bf16 v[204:207], v[84:87], v[128:131], 0
    ds_read_b64_tr_b16 v[120:121], v22 offset:6304
    ds_read_b64_tr_b16 v[122:123], v22 offset:7072
    s_add_u32 m0, s64, 43008
    s_nop 0
    buffer_load_dwordx4 v20, s[20:23], s59 offen lds
    v_mfma_f32_16x16x32_bf16 v[184:187], v[88:91], v[124:127], 0
    ds_read_b128 v[160:163], v23 offset:64
    v_mfma_f32_16x16x32_bf16 v[208:211], v[88:91], v[128:131], 0
    s_mov_b32 s58, 256
    s_add_u32 m0, s67, 0
    s_nop 0
    buffer_load_dwordx4 v16, s[16:19], s58 offen lds
    v_mfma_f32_16x16x32_bf16 v[188:191], v[92:95], v[124:127], 0
    v_mfma_f32_16x16x32_bf16 v[212:215], v[92:95], v[128:131], 0
    s_mov_b32 s58, 8448
    s_add_u32 m0, s67, 1024
    s_nop 0
    buffer_load_dwordx4 v17, s[16:19], s58 offen lds
    v_mfma_f32_16x16x32_bf16 v[192:195], v[96:99], v[124:127], 0
    v_mfma_f32_16x16x32_bf16 v[216:219], v[96:99], v[128:131], 0
    s_mov_b32 s58, 16640
    s_add_u32 m0, s67, 2048
    s_nop 0
    buffer_load_dwordx4 v16, s[16:19], s58 offen lds
    s_mov_b32 s58, 24832
    s_add_u32 m0, s67, 3072
    s_nop 0
    buffer_load_dwordx4 v17, s[16:19], s58 offen lds
    s_cmp_lg_u32 s65, 0
    s_cbranch_scc1 G1g_1
    v_mfma_f32_16x16x32_bf16 v[244:247], v[156:159], v[124:127], 0
    v_mfma_f32_16x16x32_bf16 v[248:251], v[156:159], v[128:131], 0
G1g_1:
    s_waitcnt lgkmcnt(0)
    s_waitcnt vmcnt(7)
    s_barrier
    v_mfma_f32_16x16x32_bf16 v[172:175], v[100:103], v[132:135], v[172:175]
    ds_read_b128 v[140:143], v24 offset:4096
    ds_read_b128 v[144:147], v24 offset:6144
    v_mfma_f32_16x16x32_bf16 v[196:199], v[100:103], v[136:139], v[196:199]
    ds_read_b128 v[148:151], v25 offset:4096
    ds_read_b128 v[152:155], v25 offset:6144
    s_mov_b32 s59, 528384
    s_add_u32 m0, s64, 0
    s_nop 0
    buffer_load_dwordx4 v18, s[20:23], s59 offen lds
    v_mfma_f32_16x16x32_bf16 v[176:179], v[104:107], v[132:135], v[176:179]
    ds_read_b64_tr_b16 v[76:77], v21 offset:20480
    ds_read_b64_tr_b16 v[78:79], v21 offset:21248
    v_mfma_f32_16x16x32_bf16 v[200:203], v[104:107], v[136:139], v[200:203]
    ds_read_b64_tr_b16 v[80:81], v22 offset:20512
    ds_read_b64_tr_b16 v[82:83], v22 offset:21280
    s_add_u32 m0, s64, 1024
    s_nop 0
    buffer_load_dwordx4 v19, s[20:23], s59 offen lds
    v_mfma_f32_16x16x32_bf16 v[180:183], v[108:111], v[132:135], v[180:183]
    ds_read_b64_tr_b16 v[84:85], v21 offset:20544
    ds_read_b64_tr_b16 v[86:87], v21 offset:21312
    v_mfma_f32_16x16x32_bf16 v[204:207], v[108:111], v[136:139], v[204:207]
    ds_read_b64_tr_b16 v[88:89], v22 offset:20576
    ds_read_b64_tr_b16 v[90:91], v22 offset:21344
    s_add_u32 m0, s64, 2048
    s_nop 0
    buffer_load_dwordx4 v20, s[20:23], s59 offen lds
    v_mfma_f32_16x16x32_bf16 v[184:187], v[112:115], v[132:135], v[184:187]
    ds_read_b64_tr_b16 v[92:93], v21 offset:20608
    ds_read_b64_tr_b16 v[94:95], v21 offset:21376
    v_mfma_f32_16x16x32_bf16 v[208:211], v[112:115], v[136:139], v[208:211]
    ds_read_b64_tr_b16 v[96:97], v22 offset:20640
    ds_read_b64_tr_b16 v[98:99], v22 offset:21408
    v_mfma_f32_16x16x32_bf16 v[188:191], v[116:119], v[132:135], v[188:191]
    ds_read_b128 v[156:159], v23 offset:128
    v_mfma_f32_16x16x32_bf16 v[212:215], v[116:119], v[136:139], v[212:215]
    v_mfma_f32_16x16x32_bf16 v[192:195], v[120:123], v[132:135], v[192:195]
    v_mfma_f32_16x16x32_bf16 v[216:219], v[120:123], v[136:139], v[216:219]
    s_cmp_lg_u32 s65, 0
    s_cbranch_scc1 G1g_2
    v_mfma_f32_16x16x32_bf16 v[244:247], v[160:163], v[132:135], v[244:247]
    v_mfma_f32_16x16x32_bf16 v[248:251], v[160:163], v[136:139], v[248:251]
G1g_2:
    s_waitcnt lgkmcnt(0)
    v_mfma_f32_16x16x32_bf16 v[172:175], v[76:79], v[140:143], v[172:175]
    ds_read_b64_tr_b16 v[100:101], v21 offset:26624
    ds_read_b64_tr_b16 v[102:103], v21 offset:27392
    v_mfma_f32_16x16x32_bf16 v[196:199], v[76:79], v[144:147], v[196:199]
    ds_read_b64_tr_b16 v[104:105], v22 offset:26656
    ds_read_b64_tr_b16 v[106:107], v22 offset:27424
    s_mov_b32 s58, 384
    s_add_u32 m0, s67, 4096
    s_nop 0
    buffer_load_dwordx4 v16, s[16:19], s58 offen lds
    v_mfma_f32_16x16x32_bf16 v[176:179], v[80:83], v[140:143], v[176:179]
    ds_read_b64_tr_b16 v[108:109], v21 offset:26688
    ds_read_b64_tr_b16 v[110:111], v21 offset:27456
    v_mfma_f32_16x16x32_bf16 v[200:203], v[80:83], v[144:147], v[200:203]
    ds_read_b64_tr_b16 v[112:113], v22 offset:26720
    ds_read_b64_tr_b16 v[114:115], v22 offset:27488
    s_mov_b32 s58, 8576
    s_add_u32 m0, s67, 5120
    s_nop 0
    buffer_load_dwordx4 v17, s[16:19], s58 offen lds
    v_mfma_f32_16x16x32_bf16 v[180:183], v[84:87], v[140:143], v[180:183]
    ds_read_b64_tr_b16 v[116:117], v21 offset:26752
    ds_read_b64_tr_b16 v[118:119], v21 offset:27520
    v_mfma_f32_16x16x32_bf16 v[204:207], v[84:87], v[144:147], v[204:207]
    ds_read_b64_tr_b16 v[120:121], v22 offset:26784
    ds_read_b64_tr_b16 v[122:123], v22 offset:27552
    s_mov_b32 s58, 16768
    s_add_u32 m0, s67, 6144
    s_nop 0
    buffer_load_dwordx4 v16, s[16:19], s58 offen lds
    v_mfma_f32_16x16x32_bf16 v[184:187], v[88:91], v[140:143], v[184:187]
    ds_read_b128 v[160:163], v23 offset:192
    v_mfma_f32_16x16x32_bf16 v[208:211], v[88:91], v[144:147], v[208:211]
    s_mov_b32 s58, 24960
    s_add_u32 m0, s67, 7168
    s_nop 0
    buffer_load_dwordx4 v17, s[16:19], s58 offen lds
    v_mfma_f32_16x16x32_bf16 v[188:191], v[92:95], v[140:143], v[188:191]
    v_mfma_f32_16x16x32_bf16 v[212:215], v[92:95], v[144:147], v[212:215]
    v_mfma_f32_16x16x32_bf16 v[192:195], v[96:99], v[140:143], v[192:195]
    v_mfma_f32_16x16x32_bf16 v[216:219], v[96:99], v[144:147], v[216:219]
    s_cmp_lg_u32 s65, 0
    s_cbranch_scc1 G1g_3
    v_mfma_f32_16x16x32_bf16 v[244:247], v[156:159], v[140:143], v[244:247]
    v_mfma_f32_16x16x32_bf16 v[248:251], v[156:159], v[144:147], v[248:251]
G1g_3:
    s_waitcnt lgkmcnt(0)
    s_waitcnt vmcnt(7)
    s_barrier
    v_mfma_f32_16x16x32_bf16 v[172:175], v[100:103], v[148:151], v[172:175]
    ds_read_b128 v[124:127], v24 offset:0
    ds_read_b128 v[128:131], v24 offset:2048
    v_mfma_f32_16x16x32_bf16 v[196:199], v[100:103], v[152:155], v[196:199]
    ds_read_b128 v[132:135], v25 offset:0
    ds_read_b128 v[136:139], v25 offset:2048
    s_mov_b32 s59, 704512
    s_add_u32 m0, s64, 20480
    s_nop 0
    buffer_load_dwordx4 v18, s[20:23], s59 offen lds
    v_mfma_f32_16x16x32_bf16 v[176:179], v[104:107], v[148:151], v[176:179]
    ds_read_b64_tr_b16 v[76:77], v21 offset:40960
    ds_read_b64_tr_b16 v[78:79], v21 offset:41728
    v_mfma_f32_16x16x32_bf16 v[200:203], v[104:107], v[152:155], v[200:203]
    ds_read_b64_tr_b16 v[80:81], v22 offset:40992
    ds_read_b64_tr_b16 v[82:83], v22 offset:41760
    s_add_u32 m0, s64, 21504
    s_nop 0
    buffer_load_dwordx4 v19, s[20:23], s59 offen lds
    v_mfma_f32_16x16x32_bf16 v[180:183], v[108:111], v[148:151], v[180:183]
    ds_read_b64_tr_b16 v[84:85], v21 offset:41024
    ds_read_b64_tr_b16 v[86:87], v21 offset:41792
    v_mfma_f32_16x16x32_bf16 v[204:207], v[108:111], v[152:155], v[204:207]
    ds_read_b64_tr_b16 v[88:89], v22 offset:41056
    ds_read_b64_tr_b16 v[90:91], v22 offset:41824
    s_add_u32 m0, s64, 22528
    s_nop 0
    buffer_load_dwordx4 v20, s[20:23], s59 offen lds
    v_mfma_f32_16x16x32_bf16 v[184:187], v[112:115], v[148:151], v[184:187]
    ds_read_b64_tr_b16 v[92:93], v21 offset:41088
    ds_read_b64_tr_b16 v[94:95], v21 offset:41856
    v_mfma_f32_16x16x32_bf16 v[208:211], v[112:115], v[152:155], v[208:211]
    ds_read_b64_tr_b16 v[96:97], v22 offset:41120
    ds_read_b64_tr_b16 v[98:99], v22 offset:41888
    v_mfma_f32_16x16x32_bf16 v[188:191], v[116:119], v[148:151], v[188:191]
    ds_read_b128 v[156:159], v23 offset:256
    v_mfma_f32_16x16x32_bf16 v[212:215], v[116:119], v[152:155], v[212:215]
    v_mfma_f32_16x16x32_bf16 v[192:195], v[120:123], v[148:151], v[192:195]
    v_mfma_f32_16x16x32_bf16 v[216:219], v[120:123], v[152:155], v[216:219]
    s_cmp_lg_u32 s65, 0
    s_cbranch_scc1 G1g_4
    v_mfma_f32_16x16x32_bf16 v[244:247], v[160:163], v[148:151], v[244:247]
    v_mfma_f32_16x16x32_bf16 v[248:251], v[160:163], v[152:155], v[248:251]
G1g_4:
    s_waitcnt lgkmcnt(0)
    v_mfma_f32_16x16x32_bf16 v[172:175], v[76:79], v[124:127], v[172:175]
    ds_read_b64_tr_b16 v[100:101], v21 offset:47104
    ds_read_b64_tr_b16 v[102:103], v21 offset:47872
    v_mfma_f32_16x16x32_bf16 v[196:199], v[76:79], v[128:131], v[196:199]
    ds_read_b64_tr_b16 v[104:105], v22 offset:47136
    ds_read_b64_tr_b16 v[106:107], v22 offset:47904
    s_mov_b32 s58, 512
    s_add_u32 m0, s67, 0
    s_nop 0
    buffer_load_dwordx4 v16, s[16:19], s58 offen lds
    v_mfma_f32_16x16x32_bf16 v[176:179], v[80:83], v[124:127], v[176:179]
    ds_read_b64_tr_b16 v[108:109], v21 offset:47168
    ds_read_b64_tr_b16 v[110:111], v21 offset:47936
    v_mfma_f32_16x16x32_bf16 v[200:203], v[80:83], v[128:131], v[200:203]
    ds_read_b64_tr_b16 v[112:113], v22 offset:47200
    ds_read_b64_tr_b16 v[114:115], v22 offset:47968
    s_mov_b32 s58, 8704
    s_add_u32 m0, s67, 1024
    s_nop 0
    buffer_load_dwordx4 v17, s[16:19], s58 offen lds
    v_mfma_f32_16x16x32_bf16 v[180:183], v[84:87], v[124:127], v[180:183]
    ds_read_b64_tr_b16 v[116:117], v21 offset:47232
    ds_read_b64_tr_b16 v[118:119], v21 offset:48000
    v_mfma_f32_16x16x32_bf16 v[204:207], v[84:87], v[128:131], v[204:207]
    ds_read_b64_tr_b16 v[120:121], v22 offset:47264
    ds_read_b64_tr_b16 v[122:123], v22 offset:48032
    s_mov_b32 s58, 16896
    s_add_u32 m0, s67, 2048
    s_nop 0
    buffer_load_dwordx4 v16, s[16:19], s58 offen lds
    v_mfma_f32_16x16x32_bf16 v[184:187], v[88:91], v[124:127], v[184:187]
    ds_read_b128 v[160:163], v23 offset:320
    v_mfma_f32_16x16x32_bf16 v[208:211], v[88:91], v[128:131], v[208:211]
    s_mov_b32 s58, 25088
    s_add_u32 m0, s67, 3072
    s_nop 0
    buffer_load_dwordx4 v17, s[16:19], s58 offen lds
    v_mfma_f32_16x16x32_bf16 v[188:191], v[92:95], v[124:127], v[188:191]
    v_mfma_f32_16x16x32_bf16 v[212:215], v[92:95], v[128:131], v[212:215]
    v_mfma_f32_16x16x32_bf16 v[192:195], v[96:99], v[124:127], v[192:195]
    v_mfma_f32_16x16x32_bf16 v[216:219], v[96:99], v[128:131], v[216:219]
    s_cmp_lg_u32 s65, 0
    s_cbranch_scc1 G1g_5
    v_mfma_f32_16x16x32_bf16 v[244:247], v[156:159], v[124:127], v[244:247]
    v_mfma_f32_16x16x32_bf16 v[248:251], v[156:159], v[128:131], v[248:251]
G1g_5:
    s_and_b32 s58, s53, 3
    s_lshl_b32 s58, s58, 1
    s_and_b32 s60, s54, 1
    s_add_u32 s58, s58, s60
    s_mul_i32 s58, s58, 172
    s_mul_i32 s60, s52, 43
    s_add_u32 s58, s58, s60
    s_lshl_b32 s58, s58, 10
    v_lshlrev_b32 v26, 10, v0
    s_mov_b32 exec_lo, -1
    s_mov_b32 exec_hi, 0x7ff
    buffer_load_dword v27, v26, s[32:35], s58 offen
    s_mov_b64 exec, -1
    s_waitcnt lgkmcnt(0)
    s_waitcnt vmcnt(8)
    s_barrier
    v_mfma_f32_16x16x32_bf16 v[172:175], v[100:103], v[132:135], v[172:175]
    ds_read_b128 v[140:143], v24 offset:4096
    ds_read_b128 v[144:147], v24 offset:6144
    v_mfma_f32_16x16x32_bf16 v[196:199], v[100:103], v[136:139], v[196:199]
    ds_read_b128 v[148:151], v25 offset:4096
    ds_read_b128 v[152:155], v25 offset:6144
    s_mov_b32 s59, 880640
    s_add_u32 m0, s64, 40960
    s_nop 0
    buffer_load_dwordx4 v18, s[20:23], s59 offen lds
    v_mfma_f32_16x16x32_bf16 v[176:179], v[104:107], v[132:135], v[176:179]
    ds_read_b64_tr_b16 v[76:77], v21 offset:0
    ds_read_b64_tr_b16 v[78:79], v21 offset:768
    v_mfma_f32_16x16x32_bf16 v[200:203], v[104:107], v[136:139], v[200:203]
    ds_read_b64_tr_b16 v[80:81], v22 offset:32
    ds_read_b64_tr_b16 v[82:83], v22 offset:800
    s_add_u32 m0, s64, 41984
    s_nop 0
    buffer_load_dwordx4 v19, s[20:23], s59 offen lds
    v_mfma_f32_16x16x32_bf16 v[180:183], v[108:111], v[132:135], v[180:183]
    ds_read_b64_tr_b16 v[84:85], v21 offset:64
    ds_read_b64_tr_b16 v[86:87], v21 offset:832
    v_mfma_f32_16x16x32_bf16 v[204:207], v[108:111], v[136:139], v[204:207]
    ds_read_b64_tr_b16 v[88:89], v22 offset:96
    ds_read_b64_tr_b16 v[90:91], v22 offset:864
    s_add_u32 m0, s64, 43008
    s_nop 0
    buffer_load_dwordx4 v20, s[20:23], s59 offen lds
    v_mfma_f32_16x16x32_bf16 v[184:187], v[112:115], v[132:135], v[184:187]
    ds_read_b64_tr_b16 v[92:93], v21 offset:128
    ds_read_b64_tr_b16 v[94:95], v21 offset:896
    v_mfma_f32_16x16x32_bf16 v[208:211], v[112:115], v[136:139], v[208:211]
    ds_read_b64_tr_b16 v[96:97], v22 offset:160
    ds_read_b64_tr_b16 v[98:99], v22 offset:928
    v_mfma_f32_16x16x32_bf16 v[188:191], v[116:119], v[132:135], v[188:191]
    ds_read_b128 v[156:159], v23 offset:384
    v_mfma_f32_16x16x32_bf16 v[212:215], v[116:119], v[136:139], v[212:215]
    v_mfma_f32_16x16x32_bf16 v[192:195], v[120:123], v[132:135], v[192:195]
    v_mfma_f32_16x16x32_bf16 v[216:219], v[120:123], v[136:139], v[216:219]
    s_cmp_lg_u32 s65, 0
    s_cbranch_scc1 G1g_6
    v_mfma_f32_16x16x32_bf16 v[244:247], v[160:163], v[132:135], v[244:247]
    v_mfma_f32_16x16x32_bf16 v[248:251], v[160:163], v[136:139], v[248:251]
G1g_6:
    s_waitcnt lgkmcnt(0)
    v_mfma_f32_16x16x32_bf16 v[172:175], v[76:79], v[140:143], v[172:175]
    ds_read_b64_tr_b16 v[100:101], v21 offset:6144
    ds_read_b64_tr_b16 v[102:103], v21 offset:6912
    v_mfma_f32_16x16x32_bf16 v[196:199], v[76:79], v[144:147], v[196:199]
    ds_read_b64_tr_b16 v[104:105], v22 offset:6176
    ds_read_b64_tr_b16 v[106:107], v22 offset:6944
    s_mov_b32 s58, 640
    s_add_u32 m0, s67, 4096
    s_nop 0
    buffer_load_dwordx4 v16, s[16:19], s58 offen lds
    v_mfma_f32_16x16x32_bf16 v[176:179], v[80:83], v[140:143], v[176:179]
    ds_read_b64_tr_b16 v[108:109], v21 offset:6208
    ds_read_b64_tr_b16 v[110:111], v21 offset:6976
    v_mfma_f32_16x16x32_bf16 v[200:203], v[80:83], v[144:147], v[200:203]
    ds_read_b64_tr_b16 v[112:113], v22 offset:6240
    ds_read_b64_tr_b16 v[114:115], v22 offset:7008
    s_mov_b32 s58, 8832
    s_add_u32 m0, s67, 5120
    s_nop 0
    buffer_load_dwordx4 v17, s[16:19], s58 offen lds
    v_mfma_f32_16x16x32_bf16 v[180:183], v[84:87], v[140:143], v[180:183]
    ds_read_b64_tr_b16 v[116:117], v21 offset:6272
    ds_read_b64_tr_b16 v[118:119], v21 offset:7040
    v_mfma_f32_16x16x32_bf16 v[204:207], v[84:87], v[144:147], v[204:207]
    ds_read_b64_tr_b16 v[120:121], v22 offset:6304
    ds_read_b64_tr_b16 v[122:123], v22 offset:7072
    s_mov_b32 s58, 17024
    s_add_u32 m0, s67, 6144
    s_nop 0
    buffer_load_dwordx4 v16, s[16:19], s58 offen lds
    v_mfma_f32_16x16x32_bf16 v[184:187], v[88:91], v[140:143], v[184:187]
    ds_read_b128 v[160:163], v23 offset:448
    v_mfma_f32_16x16x32_bf16 v[208:211], v[88:91], v[144:147], v[208:211]
    s_mov_b32 s58, 25216
    s_add_u32 m0, s67, 7168
    s_nop 0
    buffer_load_dwordx4 v17, s[16:19], s58 offen lds
    v_mfma_f32_16x16x32_bf16 v[188:191], v[92:95], v[140:143], v[188:191]
    v_mfma_f32_16x16x32_bf16 v[212:215], v[92:95], v[144:147], v[212:215]
    v_mfma_f32_16x16x32_bf16 v[192:195], v[96:99], v[140:143], v[192:195]
    v_mfma_f32_16x16x32_bf16 v[216:219], v[96:99], v[144:147], v[216:219]
    s_cmp_lg_u32 s65, 0
    s_cbranch_scc1 G1g_7
    v_mfma_f32_16x16x32_bf16 v[244:247], v[156:159], v[140:143], v[244:247]
    v_mfma_f32_16x16x32_bf16 v[248:251], v[156:159], v[144:147], v[248:251]
G1g_7:
    s_waitcnt lgkmcnt(0)
    s_waitcnt vmcnt(8)
    s_barrier
    v_mfma_f32_16x16x32_bf16 v[172:175], v[100:103], v[148:151], v[172:175]
    ds_read_b128 v[124:127], v24 offset:0
    ds_read_b128 v[128:131], v24 offset:2048
    v_mfma_f32_16x16x32_bf16 v[196:199], v[100:103], v[152:155], v[196:199]
    ds_read_b128 v[132:135], v25 offset:0
    ds_read_b128 v[136:139], v25 offset:2048
    s_mov_b32 s59, 1056768
    s_add_u32 m0, s64, 0
    s_nop 0
    buffer_load_dwordx4 v18, s[20:23], s59 offen lds
    v_mfma_f32_16x16x32_bf16 v[176:179], v[104:107], v[148:151], v[176:179]
    ds_read_b64_tr_b16 v[76:77], v21 offset:20480
    ds_read_b64_tr_b16 v[78:79], v21 offset:21248
    v_mfma_f32_16x16x32_bf16 v[200:203], v[104:107], v[152:155], v[200:203]
    ds_read_b64_tr_b16 v[80:81], v22 offset:20512
    ds_read_b64_tr_b16 v[82:83], v22 offset:21280
    s_add_u32 m0, s64, 1024
    s_nop 0
    buffer_load_dwordx4 v19, s[20:23], s59 offen lds
    v_mfma_f32_16x16x32_bf16 v[180:183], v[108:111], v[148:151], v[180:183]
    ds_read_b64_tr_b16 v[84:85], v21 offset:20544
    ds_read_b64_tr_b16 v[86:87], v21 offset:21312
    v_mfma_f32_16x16x32_bf16 v[204:207], v[108:111], v[152:155], v[204:207]
    ds_read_b64_tr_b16 v[88:89], v22 offset:20576
    ds_read_b64_tr_b16 v[90:91], v22 offset:21344
    s_add_u32 m0, s64, 2048
    s_nop 0
    buffer_load_dwordx4 v20, s[20:23], s59 offen lds
    v_mfma_f32_16x16x32_bf16 v[184:187], v[112:115], v[148:151], v[184:187]
    ds_read_b64_tr_b16 v[92:93], v21 offset:20608
    ds_read_b64_tr_b16 v[94:95], v21 offset:21376
    v_mfma_f32_16x16x32_bf16 v[208:211], v[112:115], v[152:155], v[208:211]
    ds_read_b64_tr_b16 v[96:97], v22 offset:20640
    ds_read_b64_tr_b16 v[98:99], v22 offset:21408
    v_mfma_f32_16x16x32_bf16 v[188:191], v[116:119], v[148:151], v[188:191]
    ds_read_b128 v[156:159], v23 offset:512
    v_mfma_f32_16x16x32_bf16 v[212:215], v[116:119], v[152:155], v[212:215]
    v_mfma_f32_16x16x32_bf16 v[192:195], v[120:123], v[148:151], v[192:195]
    v_mfma_f32_16x16x32_bf16 v[216:219], v[120:123], v[152:155], v[216:219]
    s_cmp_lg_u32 s65, 0
    s_cbranch_scc1 G1g_8
    v_mfma_f32_16x16x32_bf16 v[244:247], v[160:163], v[148:151], v[244:247]
    v_mfma_f32_16x16x32_bf16 v[248:251], v[160:163], v[152:155], v[248:251]
G1g_8:
    s_waitcnt lgkmcnt(0)
    v_mfma_f32_16x16x32_bf16 v[172:175], v[76:79], v[124:127], v[172:175]
    ds_read_b64_tr_b16 v[100:101], v21 offset:26624
    ds_read_b64_tr_b16 v[102:103], v21 offset:27392
    v_mfma_f32_16x16x32_bf16 v[196:199], v[76:79], v[128:131], v[196:199]
    ds_read_b64_tr_b16 v[104:105], v22 offset:26656
    ds_read_b64_tr_b16 v[106:107], v22 offset:27424
    s_mov_b32 s58, 768
    s_add_u32 m0, s67, 0
    s_nop 0
    buffer_load_dwordx4 v16, s[16:19], s58 offen lds
    v_mfma_f32_16x16x32_bf16 v[176:179], v[80:83], v[124:127], v[176:179]
    ds_read_b64_tr_b16 v[108:109], v21 offset:26688
    ds_read_b64_tr_b16 v[110:111], v21 offset:27456
    v_mfma_f32_16x16x32_bf16 v[200:203], v[80:83], v[128:131], v[200:203]
    ds_read_b64_tr_b16 v[112:113], v22 offset:26720
    ds_read_b64_tr_b16 v[114:115], v22 offset:27488
    s_mov_b32 s58, 8960
    s_add_u32 m0, s67, 1024
    s_nop 0
    buffer_load_dwordx4 v17, s[16:19], s58 offen lds
    v_mfma_f32_16x16x32_bf16 v[180:183], v[84:87], v[124:127], v[180:183]
    ds_read_b64_tr_b16 v[116:117], v21 offset:26752
    ds_read_b64_tr_b16 v[118:119], v21 offset:27520
    v_mfma_f32_16x16x32_bf16 v[204:207], v[84:87], v[128:131], v[204:207]
    ds_read_b64_tr_b16 v[120:121], v22 offset:26784
    ds_read_b64_tr_b16 v[122:123], v22 offset:27552
    s_mov_b32 s58, 17152
    s_add_u32 m0, s67, 2048
    s_nop 0
    buffer_load_dwordx4 v16, s[16:19], s58 offen lds
    v_mfma_f32_16x16x32_bf16 v[184:187], v[88:91], v[124:127], v[184:187]
    ds_read_b128 v[160:163], v23 offset:576
    v_mfma_f32_16x16x32_bf16 v[208:211], v[88:91], v[128:131], v[208:211]
    s_mov_b32 s58, 25344
    s_add_u32 m0, s67, 3072
    s_nop 0
    buffer_load_dwordx4 v17, s[16:19], s58 offen lds
    v_mfma_f32_16x16x32_bf16 v[188:191], v[92:95], v[124:127], v[188:191]
    v_mfma_f32_16x16x32_bf16 v[212:215], v[92:95], v[128:131], v[212:215]
    v_mfma_f32_16x16x32_bf16 v[192:195], v[96:99], v[124:127], v[192:195]
    v_mfma_f32_16x16x32_bf16 v[216:219], v[96:99], v[128:131], v[216:219]
    s_cmp_lg_u32 s65, 0
    s_cbranch_scc1 G1g_9
    v_mfma_f32_16x16x32_bf16 v[244:247], v[156:159], v[124:127], v[244:247]
    v_mfma_f32_16x16x32_bf16 v[248:251], v[156:159], v[128:131], v[248:251]
G1g_9:
    s_waitcnt lgkmcnt(0)
    s_waitcnt vmcnt(7)
    s_barrier
    v_mfma_f32_16x16x32_bf16 v[172:175], v[100:103], v[132:135], v[172:175]
    ds_read_b128 v[140:143], v24 offset:4096
    ds_read_b128 v[144:147], v24 offset:6144
    v_mfma_f32_16x16x32_bf16 v[196:199], v[100:103], v[136:139], v[196:199]
    ds_read_b128 v[148:151], v25 offset:4096
    ds_read_b128 v[152:155], v25 offset:6144
    s_mov_b32 s59, 1232896
    s_add_u32 m0, s64, 20480
    s_nop 0
    buffer_load_dwordx4 v18, s[20:23], s59 offen lds
    v_mfma_f32_16x16x32_bf16 v[176:179], v[104:107], v[132:135], v[176:179]
    ds_read_b64_tr_b16 v[76:77], v21 offset:40960
    ds_read_b64_tr_b16 v[78:79], v21 offset:41728
    v_mfma_f32_16x16x32_bf16 v[200:203], v[104:107], v[136:139], v[200:203]
    ds_read_b64_tr_b16 v[80:81], v22 offset:40992
    ds_read_b64_tr_b16 v[82:83], v22 offset:41760
    s_add_u32 m0, s64, 21504
    s_nop 0
    buffer_load_dwordx4 v19, s[20:23], s59 offen lds
    v_mfma_f32_16x16x32_bf16 v[180:183], v[108:111], v[132:135], v[180:183]
    ds_read_b64_tr_b16 v[84:85], v21 offset:41024
    ds_read_b64_tr_b16 v[86:87], v21 offset:41792
    v_mfma_f32_16x16x32_bf16 v[204:207], v[108:111], v[136:139], v[204:207]
    ds_read_b64_tr_b16 v[88:89], v22 offset:41056
    ds_read_b64_tr_b16 v[90:91], v22 offset:41824
    s_add_u32 m0, s64, 22528
    s_nop 0
    buffer_load_dwordx4 v20, s[20:23], s59 offen lds
    v_mfma_f32_16x16x32_bf16 v[184:187], v[112:115], v[132:135], v[184:187]
    ds_read_b64_tr_b16 v[92:93], v21 offset:41088
    ds_read_b64_tr_b16 v[94:95], v21 offset:41856
    v_mfma_f32_16x16x32_bf16 v[208:211], v[112:115], v[136:139], v[208:211]
    ds_read_b64_tr_b16 v[96:97], v22 offset:41120
    ds_read_b64_tr_b16 v[98:99], v22 offset:41888
    v_mfma_f32_16x16x32_bf16 v[188:191], v[116:119], v[132:135], v[188:191]
    ds_read_b128 v[156:159], v23 offset:640
    v_mfma_f32_16x16x32_bf16 v[212:215], v[116:119], v[136:139], v[212:215]
    v_mfma_f32_16x16x32_bf16 v[192:195], v[120:123], v[132:135], v[192:195]
    v_mfma_f32_16x16x32_bf16 v[216:219], v[120:123], v[136:139], v[216:219]
    s_cmp_lg_u32 s65, 0
    s_cbranch_scc1 G1g_10
    v_mfma_f32_16x16x32_bf16 v[244:247], v[160:163], v[132:135], v[244:247]
    v_mfma_f32_16x16x32_bf16 v[248:251], v[160:163], v[136:139], v[248:251]
G1g_10:
    s_waitcnt lgkmcnt(0)
    v_mfma_f32_16x16x32_bf16 v[172:175], v[76:79], v[140:143], v[172:175]
    ds_read_b64_tr_b16 v[100:101], v21 offset:47104
    ds_read_b64_tr_b16 v[102:103], v21 offset:47872
    v_mfma_f32_16x16x32_bf16 v[196:199], v[76:79], v[144:147], v[196:199]
    ds_read_b64_tr_b16 v[104:105], v22 offset:47136
    ds_read_b64_tr_b16 v[106:107], v22 offset:47904
    s_mov_b32 s58, 896
    s_add_u32 m0, s67, 4096
    s_nop 0
    buffer_load_dwordx4 v16, s[16:19], s58 offen lds
    v_mfma_f32_16x16x32_bf16 v[176:179], v[80:83], v[140:143], v[176:179]
    ds_read_b64_tr_b16 v[108:109], v21 offset:47168
    ds_read_b64_tr_b16 v[110:111], v21 offset:47936
    v_mfma_f32_16x16x32_bf16 v[200:203], v[80:83], v[144:147], v[200:203]
    ds_read_b64_tr_b16 v[112:113], v22 offset:47200
    ds_read_b64_tr_b16 v[114:115], v22 offset:47968
    s_mov_b32 s58, 9088
    s_add_u32 m0, s67, 5120
    s_nop 0
    buffer_load_dwordx4 v17, s[16:19], s58 offen lds
    v_mfma_f32_16x16x32_bf16 v[180:183], v[84:87], v[140:143], v[180:183]
    ds_read_b64_tr_b16 v[116:117], v21 offset:47232
    ds_read_b64_tr_b16 v[118:119], v21 offset:48000
    v_mfma_f32_16x16x32_bf16 v[204:207], v[84:87], v[144:147], v[204:207]
    ds_read_b64_tr_b16 v[120:121], v22 offset:47264
    ds_read_b64_tr_b16 v[122:123], v22 offset:48032
    s_mov_b32 s58, 17280
    s_add_u32 m0, s67, 6144
    s_nop 0
    buffer_load_dwordx4 v16, s[16:19], s58 offen lds
    v_mfma_f32_16x16x32_bf16 v[184:187], v[88:91], v[140:143], v[184:187]
    ds_read_b128 v[160:163], v23 offset:704
    v_mfma_f32_16x16x32_bf16 v[208:211], v[88:91], v[144:147], v[208:211]
    s_mov_b32 s58, 25472
    s_add_u32 m0, s67, 7168
    s_nop 0
    buffer_load_dwordx4 v17, s[16:19], s58 offen lds
    v_mfma_f32_16x16x32_bf16 v[188:191], v[92:95], v[140:143], v[188:191]
    v_mfma_f32_16x16x32_bf16 v[212:215], v[92:95], v[144:147], v[212:215]
    v_mfma_f32_16x16x32_bf16 v[192:195], v[96:99], v[140:143], v[192:195]
    v_mfma_f32_16x16x32_bf16 v[216:219], v[96:99], v[144:147], v[216:219]
    s_cmp_lg_u32 s65, 0
    s_cbranch_scc1 G1g_11
    v_mfma_f32_16x16x32_bf16 v[244:247], v[156:159], v[140:143], v[244:247]
    v_mfma_f32_16x16x32_bf16 v[248:251], v[156:159], v[144:147], v[248:251]
G1g_11:
    s_waitcnt lgkmcnt(0)
    s_waitcnt vmcnt(7)
    s_barrier
    v_mfma_f32_16x16x32_bf16 v[172:175], v[100:103], v[148:151], v[172:175]
    ds_read_b128 v[124:127], v24 offset:0
    ds_read_b128 v[128:131], v24 offset:2048
    v_mfma_f32_16x16x32_bf16 v[196:199], v[100:103], v[152:155], v[196:199]
    ds_read_b128 v[132:135], v25 offset:0
    ds_read_b128 v[136:139], v25 offset:2048
    v_mfma_f32_16x16x32_bf16 v[176:179], v[104:107], v[148:151], v[176:179]
    ds_read_b64_tr_b16 v[76:77], v21 offset:0
    ds_read_b64_tr_b16 v[78:79], v21 offset:768
    v_mfma_f32_16x16x32_bf16 v[200:203], v[104:107], v[152:155], v[200:203]
    ds_read_b64_tr_b16 v[80:81], v22 offset:32
    ds_read_b64_tr_b16 v[82:83], v22 offset:800
    v_mfma_f32_16x16x32_bf16 v[180:183], v[108:111], v[148:151], v[180:183]
    ds_read_b64_tr_b16 v[84:85], v21 offset:64
    ds_read_b64_tr_b16 v[86:87], v21 offset:832
    v_mfma_f32_16x16x32_bf16 v[204:207], v[108:111], v[152:155], v[204:207]
    ds_read_b64_tr_b16 v[88:89], v22 offset:96
    ds_read_b64_tr_b16 v[90:91], v22 offset:864
    v_mfma_f32_16x16x32_bf16 v[184:187], v[112:115], v[148:151], v[184:187]
    ds_read_b64_tr_b16 v[92:93], v21 offset:128
    ds_read_b64_tr_b16 v[94:95], v21 offset:896
    v_mfma_f32_16x16x32_bf16 v[208:211], v[112:115], v[152:155], v[208:211]
    ds_read_b64_tr_b16 v[96:97], v22 offset:160
    ds_read_b64_tr_b16 v[98:99], v22 offset:928
    v_mfma_f32_16x16x32_bf16 v[188:191], v[116:119], v[148:151], v[188:191]
    ds_read_b128 v[156:159], v23 offset:768
    v_mfma_f32_16x16x32_bf16 v[212:215], v[116:119], v[152:155], v[212:215]
    v_mfma_f32_16x16x32_bf16 v[192:195], v[120:123], v[148:151], v[192:195]
    v_mfma_f32_16x16x32_bf16 v[216:219], v[120:123], v[152:155], v[216:219]
    s_cmp_lg_u32 s65, 0
    s_cbranch_scc1 G1g_12
    v_mfma_f32_16x16x32_bf16 v[244:247], v[160:163], v[148:151], v[244:247]
    v_mfma_f32_16x16x32_bf16 v[248:251], v[160:163], v[152:155], v[248:251]
G1g_12:
    s_waitcnt lgkmcnt(0)
    v_mfma_f32_16x16x32_bf16 v[172:175], v[76:79], v[124:127], v[172:175]
    ds_read_b64_tr_b16 v[100:101], v21 offset:6144
    ds_read_b64_tr_b16 v[102:103], v21 offset:6912
    v_mfma_f32_16x16x32_bf16 v[196:199], v[76:79], v[128:131], v[196:199]
    ds_read_b64_tr_b16 v[104:105], v22 offset:6176
    ds_read_b64_tr_b16 v[106:107], v22 offset:6944
    s_add_u32 s68, s66, 0
    s_lshl_b32 s68, s68, 15
    s_add_u32 m0, s67, 0
    s_nop 0
    buffer_load_dwordx4 v1, s[32:35], s68 offen lds
    v_mfma_f32_16x16x32_bf16 v[176:179], v[80:83], v[124:127], v[176:179]
    ds_read_b64_tr_b16 v[108:109], v21 offset:6208
    ds_read_b64_tr_b16 v[110:111], v21 offset:6976
    v_mfma_f32_16x16x32_bf16 v[200:203], v[80:83], v[128:131], v[200:203]
    ds_read_b64_tr_b16 v[112:113], v22 offset:6240
    ds_read_b64_tr_b16 v[114:115], v22 offset:7008
    s_add_u32 s68, s68, 8192
    s_add_u32 m0, s67, 1024
    s_nop 0
    buffer_load_dwordx4 v1, s[32:35], s68 offen lds
    v_mfma_f32_16x16x32_bf16 v[180:183], v[84:87], v[124:127], v[180:183]
    ds_read_b64_tr_b16 v[116:117], v21 offset:6272
    ds_read_b64_tr_b16 v[118:119], v21 offset:7040
    v_mfma_f32_16x16x32_bf16 v[204:207], v[84:87], v[128:131], v[204:207]
    ds_read_b64_tr_b16 v[120:121], v22 offset:6304
    ds_read_b64_tr_b16 v[122:123], v22 offset:7072
    s_add_u32 s68, s68, 8192
    s_add_u32 m0, s67, 2048
    s_nop 0
    buffer_load_dwordx4 v1, s[32:35], s68 offen lds
    v_mfma_f32_16x16x32_bf16 v[184:187], v[88:91], v[124:127], v[184:187]
    ds_read_b128 v[160:163], v23 offset:832
    v_mfma_f32_16x16x32_bf16 v[208:211], v[88:91], v[128:131], v[208:211]
    s_add_u32 s68, s68, 8192
    s_add_u32 m0, s67, 3072
    s_nop 0
    buffer_load_dwordx4 v1, s[32:35], s68 offen lds
    v_mfma_f32_16x16x32_bf16 v[188:191], v[92:95], v[124:127], v[188:191]
    v_mfma_f32_16x16x32_bf16 v[212:215], v[92:95], v[128:131], v[212:215]
    v_mfma_f32_16x16x32_bf16 v[192:195], v[96:99], v[124:127], v[192:195]
    v_mfma_f32_16x16x32_bf16 v[216:219], v[96:99], v[128:131], v[216:219]
    s_cmp_lg_u32 s65, 0
    s_cbranch_scc1 G1g_13
    v_mfma_f32_16x16x32_bf16 v[244:247], v[156:159], v[124:127], v[244:247]
    v_mfma_f32_16x16x32_bf16 v[248:251], v[156:159], v[128:131], v[248:251]
G1g_13:
    s_lshl_b32 s58, s53, 3
    s_lshl_b32 s59, s52, 1
    s_add_u32 s58, s58, s59
    s_mul_i32 s58, s58, 43
    s_add_u32 s58, s58, s57
    s_lshl_b32 s71, s58, 10
    s_mul_i32 s62, s63, 0x9E3779B1
    s_add_u32 s62, s62, 0x7F4A7C15
    s_mov_b32 s28, s14
    s_mov_b32 s29, s15
    s_mov_b32 s30, 5636096
    s_mov_b32 s31, 0x20000
    s_mov_b32 s36, s14
    s_mov_b32 s37, s15
    s_mov_b32 s38, 5636096
    s_mov_b32 s39, 0x20000
    s_cmp_lt_u32 s54, 5
    s_cselect_b32 s38, 0, s38
    s_waitcnt lgkmcnt(0)
    s_waitcnt vmcnt(4)
    s_barrier
    v_mfma_f32_16x16x32_bf16 v[172:175], v[100:103], v[132:135], v[172:175]
    ds_read_b128 v[140:143], v24 offset:4096
    ds_read_b128 v[144:147], v24 offset:6144
    v_mfma_f32_16x16x32_bf16 v[196:199], v[100:103], v[136:139], v[196:199]
    ds_read_b128 v[148:151], v25 offset:4096
    ds_read_b128 v[152:155], v25 offset:6144
    v_mfma_f32_16x16x32_bf16 v[176:179], v[104:107], v[132:135], v[176:179]
    ds_read_b64_tr_b16 v[76:77], v21 offset:20480
    ds_read_b64_tr_b16 v[78:79], v21 offset:21248
    v_mfma_f32_16x16x32_bf16 v[200:203], v[104:107], v[136:139], v[200:203]
    ds_read_b64_tr_b16 v[80:81], v22 offset:20512
    ds_read_b64_tr_b16 v[82:83], v22 offset:21280
    v_mfma_f32_16x16x32_bf16 v[180:183], v[108:111], v[132:135], v[180:183]
    ds_read_b64_tr_b16 v[84:85], v21 offset:20544
    ds_read_b64_tr_b16 v[86:87], v21 offset:21312
    v_mfma_f32_16x16x32_bf16 v[204:207], v[108:111], v[136:139], v[204:207]
    ds_read_b64_tr_b16 v[88:89], v22 offset:20576
    ds_read_b64_tr_b16 v[90:91], v22 offset:21344
    v_mfma_f32_16x16x32_bf16 v[184:187], v[112:115], v[132:135], v[184:187]
    ds_read_b64_tr_b16 v[92:93], v21 offset:20608
    ds_read_b64_tr_b16 v[94:95], v21 offset:21376
    v_mfma_f32_16x16x32_bf16 v[208:211], v[112:115], v[136:139], v[208:211]
    ds_read_b64_tr_b16 v[96:97], v22 offset:20640
    ds_read_b64_tr_b16 v[98:99], v22 offset:21408
    v_mfma_f32_16x16x32_bf16 v[188:191], v[116:119], v[132:135], v[188:191]
    ds_read_b128 v[156:159], v23 offset:896
    v_mfma_f32_16x16x32_bf16 v[212:215], v[116:119], v[136:139], v[212:215]
    v_mfma_f32_16x16x32_bf16 v[192:195], v[120:123], v[132:135], v[192:195]
    v_mfma_f32_16x16x32_bf16 v[216:219], v[120:123], v[136:139], v[216:219]
    s_cmp_lg_u32 s65, 0
    s_cbranch_scc1 G1g_14
    v_mfma_f32_16x16x32_bf16 v[244:247], v[160:163], v[132:135], v[244:247]
    v_mfma_f32_16x16x32_bf16 v[248:251], v[160:163], v[136:139], v[248:251]
G1g_14:
    s_waitcnt lgkmcnt(0)
    v_mfma_f32_16x16x32_bf16 v[172:175], v[76:79], v[140:143], v[172:175]
    ds_read_b64_tr_b16 v[100:101], v21 offset:26624
    ds_read_b64_tr_b16 v[102:103], v21 offset:27392
    v_mfma_f32_16x16x32_bf16 v[196:199], v[76:79], v[144:147], v[196:199]
    ds_read_b64_tr_b16 v[104:105], v22 offset:26656
    ds_read_b64_tr_b16 v[106:107], v22 offset:27424
    s_add_u32 s68, s66, 1
    s_lshl_b32 s68, s68, 15
    s_add_u32 m0, s67, 4096
    s_nop 0
    buffer_load_dwordx4 v1, s[32:35], s68 offen lds
    v_mfma_f32_16x16x32_bf16 v[176:179], v[80:83], v[140:143], v[176:179]
    ds_read_b64_tr_b16 v[108:109], v21 offset:26688
    ds_read_b64_tr_b16 v[110:111], v21 offset:27456
    v_mfma_f32_16x16x32_bf16 v[200:203], v[80:83], v[144:147], v[200:203]
    ds_read_b64_tr_b16 v[112:113], v22 offset:26720
    ds_read_b64_tr_b16 v[114:115], v22 offset:27488
    s_add_u32 s68, s68, 8192
    s_add_u32 m0, s67, 5120
    s_nop 0
    buffer_load_dwordx4 v1, s[32:35], s68 offen lds
    v_mfma_f32_16x16x32_bf16 v[180:183], v[84:87], v[140:143], v[180:183]
    ds_read_b64_tr_b16 v[116:117], v21 offset:26752
    ds_read_b64_tr_b16 v[118:119], v21 offset:27520
    v_mfma_f32_16x16x32_bf16 v[204:207], v[84:87], v[144:147], v[204:207]
    ds_read_b64_tr_b16 v[120:121], v22 offset:26784
    ds_read_b64_tr_b16 v[122:123], v22 offset:27552
    s_add_u32 s68, s68, 8192
    s_add_u32 m0, s67, 6144
    s_nop 0
    buffer_load_dwordx4 v1, s[32:35], s68 offen lds
    v_mfma_f32_16x16x32_bf16 v[184:187], v[88:91], v[140:143], v[184:187]
    ds_read_b128 v[160:163], v23 offset:960
    v_mfma_f32_16x16x32_bf16 v[208:211], v[88:91], v[144:147], v[208:211]
    s_add_u32 s68, s68, 8192
    s_add_u32 m0, s67, 7168
    s_nop 0
    buffer_load_dwordx4 v1, s[32:35], s68 offen lds
    v_mfma_f32_16x16x32_bf16 v[188:191], v[92:95], v[140:143], v[188:191]
    v_mfma_f32_16x16x32_bf16 v[212:215], v[92:95], v[144:147], v[212:215]
    v_mfma_f32_16x16x32_bf16 v[192:195], v[96:99], v[140:143], v[192:195]
    v_mfma_f32_16x16x32_bf16 v[216:219], v[96:99], v[144:147], v[216:219]
    s_cmp_lg_u32 s65, 0
    s_cbranch_scc1 G1g_15
    v_mfma_f32_16x16x32_bf16 v[244:247], v[156:159], v[140:143], v[244:247]
    v_mfma_f32_16x16x32_bf16 v[248:251], v[156:159], v[144:147], v[248:251]
G1g_15:
    s_waitcnt lgkmcnt(0)
    s_barrier
    s_cmp_lg_u32 s65, 0
    s_cbranch_scc1 G1g_16
    v_mfma_f32_16x16x32_bf16 v[244:247], v[160:163], v[148:151], v[244:247]
    v_mfma_f32_16x16x32_bf16 v[248:251], v[160:163], v[152:155], v[248:251]
G1g_16:
    v_mfma_f32_16x16x32_bf16 v[172:175], v[100:103], v[148:151], v[172:175]
    v_mfma_f32_16x16x32_bf16 v[196:199], v[100:103], v[152:155], v[196:199]
    v_mfma_f32_16x16x32_bf16 v[176:179], v[104:107], v[148:151], v[176:179]
    v_mfma_f32_16x16x32_bf16 v[200:203], v[104:107], v[152:155], v[200:203]
    v_mfma_f32_16x16x32_bf16 v[180:183], v[108:111], v[148:151], v[180:183]
    v_mfma_f32_16x16x32_bf16 v[204:207], v[108:111], v[152:155], v[204:207]
    v_mfma_f32_16x16x32_bf16 v[184:187], v[112:115], v[148:151], v[184:187]
    v_mfma_f32_16x16x32_bf16 v[208:211], v[112:115], v[152:155], v[208:211]
    s_nop 3
    v_cvt_pk_bf16_f32 v220, v172, v173
    v_cvt_pk_bf16_f32 v221, v174, v175
    v_cvt_pk_bf16_f32 v222, v176, v177
    v_cvt_pk_bf16_f32 v223, v178, v179
    v_pk_max_i16 v220, v220, 0
    v_pk_max_i16 v221, v221, 0
    v_pk_max_i16 v222, v222, 0
    v_pk_max_i16 v223, v223, 0
    s_add_u32 s59, s71, 0
    buffer_store_dwordx4 v[220:223], v6, s[28:31], s59 offen sc1
    v_cvt_pk_bf16_f32 v224, v196, v197
    v_cvt_pk_bf16_f32 v225, v198, v199
    v_cvt_pk_bf16_f32 v226, v200, v201
    v_cvt_pk_bf16_f32 v227, v202, v203
    v_pk_max_i16 v224, v224, 0
    v_pk_max_i16 v225, v225, 0
    v_pk_max_i16 v226, v226, 0
    v_pk_max_i16 v227, v227, 0
    s_add_u32 s59, s71, 44032
    buffer_store_dwordx4 v[224:227], v6, s[28:31], s59 offen sc1
    v_mfma_f32_16x16x32_bf16 v[188:191], v[116:119], v[148:151], v[188:191]
    v_mfma_f32_16x16x32_bf16 v[212:215], v[116:119], v[152:155], v[212:215]
    v_mfma_f32_16x16x32_bf16 v[192:195], v[120:123], v[148:151], v[192:195]
    v_mfma_f32_16x16x32_bf16 v[216:219], v[120:123], v[152:155], v[216:219]
    v_cvt_pk_bf16_f32 v228, v180, v181
    v_cvt_pk_bf16_f32 v229, v182, v183
    v_cvt_pk_bf16_f32 v230, v184, v185
    v_cvt_pk_bf16_f32 v231, v186, v187
    v_pk_max_i16 v228, v228, 0
    v_pk_max_i16 v229, v229, 0
    v_pk_max_i16 v230, v230, 0
    v_pk_max_i16 v231, v231, 0
    s_add_u32 s59, s71, 1024
    buffer_store_dwordx4 v[228:231], v6, s[28:31], s59 offen sc1
    v_cvt_pk_bf16_f32 v232, v204, v205
    v_cvt_pk_bf16_f32 v233, v206, v207
    v_cvt_pk_bf16_f32 v234, v208, v209
    v_cvt_pk_bf16_f32 v235, v210, v211
    v_pk_max_i16 v232, v232, 0
    v_pk_max_i16 v233, v233, 0
    v_pk_max_i16 v234, v234, 0
    v_pk_max_i16 v235, v235, 0
    s_add_u32 s59, s71, 45056
    buffer_store_dwordx4 v[232:235], v6, s[28:31], s59 offen sc1
    v_cvt_pk_bf16_f32 v236, v188, v189
    v_cvt_pk_bf16_f32 v237, v190, v191
    v_cvt_pk_bf16_f32 v238, v192, v193
    v_cvt_pk_bf16_f32 v239, v194, v195
    v_pk_max_i16 v236, v236, 0
    v_pk_max_i16 v237, v237, 0
    v_pk_max_i16 v238, v238, 0
    v_pk_max_i16 v239, v239, 0
    s_add_u32 s59, s71, 2048
    buffer_store_dwordx4 v[236:239], v6, s[36:39], s59 offen sc1
    v_cvt_pk_bf16_f32 v240, v212, v213
    v_cvt_pk_bf16_f32 v241, v214, v215
    v_cvt_pk_bf16_f32 v242, v216, v217
    v_cvt_pk_bf16_f32 v243, v218, v219
    v_pk_max_i16 v240, v240, 0
    v_pk_max_i16 v241, v241, 0
    v_pk_max_i16 v242, v242, 0
    v_pk_max_i16 v243, v243, 0
    s_add_u32 s59, s71, 46080
    buffer_store_dwordx4 v[240:243], v6, s[36:39], s59 offen sc1
    s_add_u32 s68, s66, 2
    s_lshl_b32 s68, s68, 15
    s_add_u32 m0, s67, 8192
    s_nop 0
    buffer_load_dwordx4 v1, s[32:35], s68 offen lds
    s_add_u32 s68, s68, 8192
    s_add_u32 m0, s67, 9216
    s_nop 0
    buffer_load_dwordx4 v1, s[32:35], s68 offen lds
    s_add_u32 s68, s68, 8192
    s_add_u32 m0, s67, 10240
    s_nop 0
    buffer_load_dwordx4 v1, s[32:35], s68 offen lds
    s_add_u32 s68, s68, 8192
    s_add_u32 m0, s67, 11264
    s_nop 0
    buffer_load_dwordx4 v1, s[32:35], s68 offen lds
    s_add_u32 s68, s66, 3
    s_lshl_b32 s68, s68, 15
    s_add_u32 m0, s67, 12288
    s_nop 0
    buffer_load_dwordx4 v1, s[32:35], s68 offen lds
    s_add_u32 s68, s68, 8192
    s_add_u32 m0, s67, 13312
    s_nop 0
    buffer_load_dwordx4 v1, s[32:35], s68 offen lds
    s_add_u32 s68, s68, 8192
    s_add_u32 m0, s67, 14336
    s_nop 0
    buffer_load_dwordx4 v1, s[32:35], s68 offen lds
    s_add_u32 s68, s68, 8192
    s_add_u32 m0, s67, 15360
    s_nop 0
    buffer_load_dwordx4 v1, s[32:35], s68 offen lds
    v_lshrrev_b32 v12, 4, v0
    v_bfe_u32 v13, v0, 2, 2
    v_lshl_add_u32 v14, v12, 2, v13
    v_lshlrev_b32 v15, 7, v14
    v_bfe_u32 v14, v14, 1, 2
    v_lshl_add_u32 v15, v14, 5, v15
    v_and_b32 v14, 3, v0
    v_lshl_add_u32 v15, v14, 3, v15
    v_add_u32 v2, s67, v15
    v_xor_b32 v3, 32, v2
    v_xor_b32 v4, 64, v2
    v_xor_b32 v5, 0x60, v2
    s_waitcnt vmcnt(18)
    ds_read_b64_tr_b16 v[76:77], v2 offset:0
    ds_read_b64_tr_b16 v[78:79], v2 offset:2048
    ds_read_b64_tr_b16 v[80:81], v3 offset:0
    ds_read_b64_tr_b16 v[82:83], v3 offset:2048
    ds_read_b64_tr_b16 v[84:85], v4 offset:0
    ds_read_b64_tr_b16 v[86:87], v4 offset:2048
    ds_read_b64_tr_b16 v[88:89], v5 offset:0
    ds_read_b64_tr_b16 v[90:91], v5 offset:2048
    s_waitcnt vmcnt(14)
    ds_read_b64_tr_b16 v[92:93], v2 offset:4096
    ds_read_b64_tr_b16 v[94:95], v2 offset:6144
    ds_read_b64_tr_b16 v[96:97], v3 offset:4096
    ds_read_b64_tr_b16 v[98:99], v3 offset:6144
    ds_read_b64_tr_b16 v[100:101], v4 offset:4096
    ds_read_b64_tr_b16 v[102:103], v4 offset:6144
    ds_read_b64_tr_b16 v[104:105], v5 offset:4096
    ds_read_b64_tr_b16 v[106:107], v5 offset:6144
    s_lshl_b32 s58, s53, 4
    s_add_u32 s58, s58, s54
    s_lshl_b32 s58, s58, 2
    s_add_u32 s58, s58, s52
    s_mul_i32 s58, s58, 4
    s_add_u32 s58, s58, 458752
    v_mov_b32 v12, s62
    v_mov_b32 v13, 0
    s_waitcnt vmcnt(8)
    s_mov_b64 exec, 1
    buffer_store_dword v12, v13, s[48:51], s58 offen sc1
    s_mov_b64 exec, -1
    s_cmp_lg_u32 s65, 0
    s_cbranch_scc1 G1gate_17
    v_cvt_pk_bf16_f32 v156, v244, v248
    v_lshlrev_b32 v157, 16, v156
    v_and_b32 v158, 0xffff0000, v156
    v_mul_f32 v157, 0xbfb8aa3b, v157
    v_mul_f32 v158, 0xbfb8aa3b, v158
    v_exp_f32 v157, v157
    v_exp_f32 v158, v158
    s_nop 0
    v_add_f32 v157, 1.0, v157
    v_add_f32 v158, 1.0, v158
    v_rcp_f32 v157, v157
    v_rcp_f32 v158, v158
    s_nop 0
    v_cvt_pk_bf16_f32 v156, v157, v158
    v_lshlrev_b32 v157, 16, v156
    v_and_b32 v158, 0xffff0000, v156
    s_and_b32 s59, s52, 1
    s_mul_i32 s59, s59, 40960
    s_add_u32 s59, s59, 16384
    v_and_b32 v159, 15, v0
    v_lshlrev_b32 v159, 2, v159
    v_add_u32 v159, s59, v159
    ds_write_b32 v159, v157
    ds_write_b32 v159, v158 offset:20480
G1gate_17:
    s_waitcnt lgkmcnt(0)
    s_barrier
    v_and_b32 v9, 15, v0
    s_add_u32 s58, s67, 16384
    v_lshl_add_u32 v9, v9, 2, s58
    ds_read_b32 v7, v9
    s_setprio 0
    s_waitcnt lgkmcnt(0)
    s_add_u32 s68, s66, 4
    s_lshl_b32 s68, s68, 15
    s_add_u32 m0, s67, 16384
    s_nop 0
    buffer_load_dwordx4 v1, s[32:35], s68 offen lds
    s_add_u32 s68, s68, 8192
    s_add_u32 m0, s67, 17408
    s_nop 0
    buffer_load_dwordx4 v1, s[32:35], s68 offen lds
    s_add_u32 s68, s68, 8192
    s_add_u32 m0, s67, 18432
    s_nop 0
    buffer_load_dwordx4 v1, s[32:35], s68 offen lds
    s_add_u32 s68, s68, 8192
    s_add_u32 m0, s67, 19456
    s_nop 0
    buffer_load_dwordx4 v1, s[32:35], s68 offen lds
    s_add_u32 s68, s66, 5
    s_lshl_b32 s68, s68, 15
    s_add_u32 m0, s67, 0
    s_nop 0
    buffer_load_dwordx4 v1, s[32:35], s68 offen lds
    s_add_u32 s68, s68, 8192
    s_add_u32 m0, s67, 1024
    s_nop 0
    buffer_load_dwordx4 v1, s[32:35], s68 offen lds
    s_add_u32 s68, s68, 8192
    s_add_u32 m0, s67, 2048
    s_nop 0
    buffer_load_dwordx4 v1, s[32:35], s68 offen lds
    s_add_u32 s68, s68, 8192
    s_add_u32 m0, s67, 3072
    s_nop 0
    buffer_load_dwordx4 v1, s[32:35], s68 offen lds
    s_add_u32 s68, s66, 6
    s_lshl_b32 s68, s68, 15
    s_add_u32 m0, s67, 4096
    s_nop 0
    buffer_load_dwordx4 v1, s[32:35], s68 offen lds
    s_add_u32 s68, s68, 8192
    s_add_u32 m0, s67, 5120
    s_nop 0
    buffer_load_dwordx4 v1, s[32:35], s68 offen lds
    s_add_u32 s68, s68, 8192
    s_add_u32 m0, s67, 6144
    s_nop 0
    buffer_load_dwordx4 v1, s[32:35], s68 offen lds
    s_add_u32 s68, s68, 8192
    s_add_u32 m0, s67, 7168
    s_nop 0
    buffer_load_dwordx4 v1, s[32:35], s68 offen lds
    s_waitcnt vmcnt(17)
    ds_read_b64_tr_b16 v[108:109], v2 offset:8192
    ds_read_b64_tr_b16 v[110:111], v2 offset:10240
    ds_read_b64_tr_b16 v[112:113], v3 offset:8192
    ds_read_b64_tr_b16 v[114:115], v3 offset:10240
    ds_read_b64_tr_b16 v[116:117], v4 offset:8192
    ds_read_b64_tr_b16 v[118:119], v4 offset:10240
    ds_read_b64_tr_b16 v[120:121], v5 offset:8192
    ds_read_b64_tr_b16 v[122:123], v5 offset:10240
    s_waitcnt lgkmcnt(0)
    s_add_u32 s68, s66, 7
    s_lshl_b32 s68, s68, 15
    s_add_u32 m0, s67, 8192
    s_nop 0
    buffer_load_dwordx4 v1, s[32:35], s68 offen lds
    s_add_u32 s68, s68, 8192
    s_add_u32 m0, s67, 9216
    s_nop 0
    buffer_load_dwordx4 v1, s[32:35], s68 offen lds
    s_add_u32 s68, s68, 8192
    s_add_u32 m0, s67, 10240
    s_nop 0
    buffer_load_dwordx4 v1, s[32:35], s68 offen lds
    s_add_u32 s68, s68, 8192
    s_add_u32 m0, s67, 11264
    s_nop 0
    buffer_load_dwordx4 v1, s[32:35], s68 offen lds
    s_waitcnt vmcnt(17)
    ds_read_b64_tr_b16 v[124:125], v2 offset:12288
    ds_read_b64_tr_b16 v[126:127], v2 offset:14336
    ds_read_b64_tr_b16 v[128:129], v3 offset:12288
    ds_read_b64_tr_b16 v[130:131], v3 offset:14336
    ds_read_b64_tr_b16 v[132:133], v4 offset:12288
    ds_read_b64_tr_b16 v[134:135], v4 offset:14336
    ds_read_b64_tr_b16 v[136:137], v5 offset:12288
    ds_read_b64_tr_b16 v[138:139], v5 offset:14336
    s_waitcnt lgkmcnt(0)
    s_add_u32 s68, s66, 8
    s_lshl_b32 s68, s68, 15
    s_add_u32 m0, s67, 12288
    s_nop 0
    buffer_load_dwordx4 v1, s[32:35], s68 offen lds
    s_add_u32 s68, s68, 8192
    s_add_u32 m0, s67, 13312
    s_nop 0
    buffer_load_dwordx4 v1, s[32:35], s68 offen lds
    s_add_u32 s68, s68, 8192
    s_add_u32 m0, s67, 14336
    s_nop 0
    buffer_load_dwordx4 v1, s[32:35], s68 offen lds
    s_add_u32 s68, s68, 8192
    s_add_u32 m0, s67, 15360
    s_nop 0
    buffer_load_dwordx4 v1, s[32:35], s68 offen lds
    s_waitcnt vmcnt(16)
    ds_read_b64_tr_b16 v[140:141], v2 offset:16384
    ds_read_b64_tr_b16 v[142:143], v2 offset:18432
    ds_read_b64_tr_b16 v[144:145], v3 offset:16384
    ds_read_b64_tr_b16 v[146:147], v3 offset:18432
    ds_read_b64_tr_b16 v[148:149], v4 offset:16384
    ds_read_b64_tr_b16 v[150:151], v4 offset:18432
    ds_read_b64_tr_b16 v[152:153], v5 offset:16384
    ds_read_b64_tr_b16 v[154:155], v5 offset:18432
    s_waitcnt lgkmcnt(0)
    s_add_u32 s68, s66, 9
    s_lshl_b32 s68, s68, 15
    s_add_u32 m0, s67, 16384
    s_nop 0
    buffer_load_dwordx4 v1, s[32:35], s68 offen lds
    s_add_u32 s68, s68, 8192
    s_add_u32 m0, s67, 17408
    s_nop 0
    buffer_load_dwordx4 v1, s[32:35], s68 offen lds
    s_add_u32 s68, s68, 8192
    s_add_u32 m0, s67, 18432
    s_nop 0
    buffer_load_dwordx4 v1, s[32:35], s68 offen lds
    s_add_u32 s68, s68, 8192
    s_add_u32 m0, s67, 19456
    s_nop 0
    buffer_load_dwordx4 v1, s[32:35], s68 offen lds
    v_bfe_u32 v8, v0, 1, 4
    v_and_b32 v9, 1, v0
    v_lshl_add_u32 v8, v8, 2, v9
    v_mul_u32_u24 v8, 4, v8
    s_and_b32 s58, s54, 1
    s_lshl_b32 s58, s58, 1
    s_lshl_b32 s59, s53, 6
    s_add_u32 s59, s59, s58
    s_mul_i32 s59, s59, 4
    s_add_u32 s93, s59, 458752
    buffer_load_dword v9, v8, s[48:51], s93 offen sc1
    s_mov_b32 s28, s14
    s_mov_b32 s29, s15
    s_mov_b32 s30, 5636096
    s_mov_b32 s31, 0x20000
    s_mov_b32 s36, s14
    s_mov_b32 s37, s15
    s_mov_b32 s38, 5636096
    s_mov_b32 s39, 0x20000
    s_cmp_eq_u32 s52, 3
    s_cselect_b32 s38, 0, s38
    s_add_u32 s58, s52, 0
    s_and_b32 s58, s58, 3
    s_lshl_b32 s60, s55, 2
    s_add_u32 s58, s58, s60
    s_mul_i32 s58, s58, 43
    s_add_u32 s58, s58, s66
    s_lshl_b32 s69, s58, 10
    s_add_u32 s58, s52, 1
    s_and_b32 s58, s58, 3
    s_lshl_b32 s60, s55, 2
    s_add_u32 s58, s58, s60
    s_mul_i32 s58, s58, 43
    s_add_u32 s58, s58, s66
    s_lshl_b32 s71, s58, 10
    s_add_u32 s58, s52, 2
    s_and_b32 s58, s58, 3
    s_lshl_b32 s60, s55, 2
    s_add_u32 s58, s58, s60
    s_mul_i32 s58, s58, 43
    s_add_u32 s58, s58, s66
    s_lshl_b32 s65, s58, 10
    s_add_u32 s58, s52, 3
    s_and_b32 s58, s58, 3
    s_lshl_b32 s60, s55, 2
    s_add_u32 s58, s58, s60
    s_mul_i32 s58, s58, 43
    s_add_u32 s58, s58, s66
    s_lshl_b32 s64, s58, 10
    s_add_u32 s40, s14, 8388608
    s_addc_u32 s41, s15, 0
    s_mov_b32 s42, 0x200000
    s_mov_b32 s43, 0x20000
    s_mov_b32 s44, s10
    s_mov_b32 s45, s11
    s_mov_b32 s46, 0x200000
    s_mov_b32 s47, 0x20000
    v_lshrrev_b32 v12, 4, v0
    v_and_b32 v13, 15, v0
    v_lshlrev_b32 v14, 14, v12
    v_lshl_add_u32 v10, v13, 2, v14
    s_lshl_b32 s70, s56, 18
    s_lshl_b32 s58, s55, 8
    s_add_u32 s70, s70, s58
    s_lshl_b32 s58, s52, 6
    s_add_u32 s70, s70, s58
    v_lshl_add_u32 v252, v0, 4, s67
    v_lshrrev_b32 v12, 2, v0
    v_and_b32 v13, 3, v0
    v_lshlrev_b32 v14, 10, v12
    v_lshl_add_u32 v254, v13, 4, v14
    v_bfe_u32 v13, v0, 1, 1
    v_and_b32 v14, 1, v0
    v_lshl_add_u32 v13, v14, 1, v13
    v_lshl_add_u32 v13, v13, 4, v12
    v_lshlrev_b32 v255, 2, v13
    s_lshl_b32 s58, s55, 16
    s_lshl_b32 s59, s52, 14
    s_add_u32 s58, s58, s59
    s_lshl_b32 s59, s56, 7
    s_add_u32 s3, s58, s59
    s_waitcnt vmcnt(0)
    s_mov_b32 s60, 2000
POLL_18:
    v_cmp_ne_u32 vcc, s62, v9
    s_cbranch_vccz POLLD_19
    s_sub_u32 s60, s60, 1
    s_cmp_eq_u32 s60, 0
    s_cbranch_scc1 POLLD_19
    buffer_load_dword v9, v8, s[48:51], s93 offen sc1
    s_waitcnt vmcnt(0)
    s_branch POLL_18
POLLD_19:
    s_setprio 2
    s_add_u32 s68, s69, 0
    buffer_load_dwordx4 v[156:159], v6, s[36:39], s68 offen sc1
    s_add_u32 s68, s71, 0
    buffer_load_dwordx4 v[160:163], v6, s[36:39], s68 offen sc1
    s_add_u32 s68, s65, 0
    buffer_load_dwordx4 v[164:167], v6, s[36:39], s68 offen sc1
    s_add_u32 s68, s64, 0
    buffer_load_dwordx4 v[168:171], v6, s[36:39], s68 offen sc1
    s_add_u32 s68, s69, 1024
    buffer_load_dwordx4 v[172:175], v6, s[28:31], s68 offen sc1
    s_add_u32 s68, s71, 1024
    buffer_load_dwordx4 v[176:179], v6, s[28:31], s68 offen sc1
    s_add_u32 s68, s65, 1024
    buffer_load_dwordx4 v[180:183], v6, s[28:31], s68 offen sc1
    s_add_u32 s68, s64, 1024
    buffer_load_dwordx4 v[184:187], v6, s[28:31], s68 offen sc1
    s_add_u32 s68, s69, 2048
    buffer_load_dwordx4 v[188:191], v6, s[28:31], s68 offen sc1
    s_add_u32 s68, s71, 2048
    buffer_load_dwordx4 v[192:195], v6, s[28:31], s68 offen sc1
    s_add_u32 s68, s65, 2048
    buffer_load_dwordx4 v[196:199], v6, s[28:31], s68 offen sc1
    s_add_u32 s68, s64, 2048
    buffer_load_dwordx4 v[200:203], v6, s[28:31], s68 offen sc1
    s_waitcnt vmcnt(8)
    s_waitcnt lgkmcnt(0)
    v_mfma_f32_16x16x32_bf16 v[12:15], v[76:79], v[156:159], 0
    v_mfma_f32_16x16x32_bf16 v[16:19], v[80:83], v[156:159], 0
    v_mfma_f32_16x16x32_bf16 v[20:23], v[84:87], v[156:159], 0
    v_mfma_f32_16x16x32_bf16 v[24:27], v[88:91], v[156:159], 0
    s_add_u32 s68, s69, 3072
    buffer_load_dwordx4 v[204:207], v6, s[28:31], s68 offen sc1
    v_mfma_f32_16x16x32_bf16 v[28:31], v[76:79], v[160:163], 0
    v_mfma_f32_16x16x32_bf16 v[32:35], v[80:83], v[160:163], 0
    v_mfma_f32_16x16x32_bf16 v[36:39], v[84:87], v[160:163], 0
    v_mfma_f32_16x16x32_bf16 v[40:43], v[88:91], v[160:163], 0
    s_add_u32 s68, s71, 3072
    buffer_load_dwordx4 v[208:211], v6, s[28:31], s68 offen sc1
    v_mfma_f32_16x16x32_bf16 v[44:47], v[76:79], v[164:167], 0
    v_mfma_f32_16x16x32_bf16 v[48:51], v[80:83], v[164:167], 0
    v_mfma_f32_16x16x32_bf16 v[52:55], v[84:87], v[164:167], 0
    v_mfma_f32_16x16x32_bf16 v[56:59], v[88:91], v[164:167], 0
    s_add_u32 s68, s65, 3072
    buffer_load_dwordx4 v[212:215], v6, s[28:31], s68 offen sc1
    v_mfma_f32_16x16x32_bf16 v[60:63], v[76:79], v[168:171], 0
    v_mfma_f32_16x16x32_bf16 v[64:67], v[80:83], v[168:171], 0
    v_mfma_f32_16x16x32_bf16 v[68:71], v[84:87], v[168:171], 0
    v_mfma_f32_16x16x32_bf16 v[72:75], v[88:91], v[168:171], 0
    s_add_u32 s68, s64, 3072
    buffer_load_dwordx4 v[216:219], v6, s[28:31], s68 offen sc1
    s_waitcnt vmcnt(8)
    s_waitcnt lgkmcnt(0)
    v_mfma_f32_16x16x32_bf16 v[12:15], v[92:95], v[172:175], v[12:15]
    v_mfma_f32_16x16x32_bf16 v[16:19], v[96:99], v[172:175], v[16:19]
    v_mfma_f32_16x16x32_bf16 v[20:23], v[100:103], v[172:175], v[20:23]
    v_mfma_f32_16x16x32_bf16 v[24:27], v[104:107], v[172:175], v[24:27]
    s_add_u32 s68, s69, 4096
    buffer_load_dwordx4 v[220:223], v6, s[28:31], s68 offen sc1
    v_mfma_f32_16x16x32_bf16 v[28:31], v[92:95], v[176:179], v[28:31]
    v_mfma_f32_16x16x32_bf16 v[32:35], v[96:99], v[176:179], v[32:35]
    v_mfma_f32_16x16x32_bf16 v[36:39], v[100:103], v[176:179], v[36:39]
    v_mfma_f32_16x16x32_bf16 v[40:43], v[104:107], v[176:179], v[40:43]
    s_add_u32 s68, s71, 4096
    buffer_load_dwordx4 v[224:227], v6, s[28:31], s68 offen sc1
    v_mfma_f32_16x16x32_bf16 v[44:47], v[92:95], v[180:183], v[44:47]
    v_mfma_f32_16x16x32_bf16 v[48:51], v[96:99], v[180:183], v[48:51]
    v_mfma_f32_16x16x32_bf16 v[52:55], v[100:103], v[180:183], v[52:55]
    v_mfma_f32_16x16x32_bf16 v[56:59], v[104:107], v[180:183], v[56:59]
    s_add_u32 s68, s65, 4096
    buffer_load_dwordx4 v[228:231], v6, s[28:31], s68 offen sc1
    v_mfma_f32_16x16x32_bf16 v[60:63], v[92:95], v[184:187], v[60:63]
    v_mfma_f32_16x16x32_bf16 v[64:67], v[96:99], v[184:187], v[64:67]
    v_mfma_f32_16x16x32_bf16 v[68:71], v[100:103], v[184:187], v[68:71]
    v_mfma_f32_16x16x32_bf16 v[72:75], v[104:107], v[184:187], v[72:75]
    s_add_u32 s68, s64, 4096
    buffer_load_dwordx4 v[232:235], v6, s[28:31], s68 offen sc1
    s_waitcnt vmcnt(8)
    s_waitcnt lgkmcnt(0)
    v_mfma_f32_16x16x32_bf16 v[12:15], v[108:111], v[188:191], v[12:15]
    v_mfma_f32_16x16x32_bf16 v[16:19], v[112:115], v[188:191], v[16:19]
    v_mfma_f32_16x16x32_bf16 v[20:23], v[116:119], v[188:191], v[20:23]
    v_mfma_f32_16x16x32_bf16 v[24:27], v[120:123], v[188:191], v[24:27]
    s_add_u32 s68, s69, 5120
    buffer_load_dwordx4 v[236:239], v6, s[28:31], s68 offen sc1
    v_mfma_f32_16x16x32_bf16 v[28:31], v[108:111], v[192:195], v[28:31]
    v_mfma_f32_16x16x32_bf16 v[32:35], v[112:115], v[192:195], v[32:35]
    v_mfma_f32_16x16x32_bf16 v[36:39], v[116:119], v[192:195], v[36:39]
    v_mfma_f32_16x16x32_bf16 v[40:43], v[120:123], v[192:195], v[40:43]
    s_add_u32 s68, s71, 5120
    buffer_load_dwordx4 v[240:243], v6, s[28:31], s68 offen sc1
    v_mfma_f32_16x16x32_bf16 v[44:47], v[108:111], v[196:199], v[44:47]
    v_mfma_f32_16x16x32_bf16 v[48:51], v[112:115], v[196:199], v[48:51]
    v_mfma_f32_16x16x32_bf16 v[52:55], v[116:119], v[196:199], v[52:55]
    v_mfma_f32_16x16x32_bf16 v[56:59], v[120:123], v[196:199], v[56:59]
    s_add_u32 s68, s65, 5120
    buffer_load_dwordx4 v[244:247], v6, s[28:31], s68 offen sc1
    v_mfma_f32_16x16x32_bf16 v[60:63], v[108:111], v[200:203], v[60:63]
    v_mfma_f32_16x16x32_bf16 v[64:67], v[112:115], v[200:203], v[64:67]
    v_mfma_f32_16x16x32_bf16 v[68:71], v[116:119], v[200:203], v[68:71]
    v_mfma_f32_16x16x32_bf16 v[72:75], v[120:123], v[200:203], v[72:75]
    s_add_u32 s68, s64, 5120
    buffer_load_dwordx4 v[248:251], v6, s[28:31], s68 offen sc1
    s_waitcnt vmcnt(8)
    s_waitcnt lgkmcnt(0)
    v_mfma_f32_16x16x32_bf16 v[12:15], v[124:127], v[204:207], v[12:15]
    v_mfma_f32_16x16x32_bf16 v[16:19], v[128:131], v[204:207], v[16:19]
    v_mfma_f32_16x16x32_bf16 v[20:23], v[132:135], v[204:207], v[20:23]
    v_mfma_f32_16x16x32_bf16 v[24:27], v[136:139], v[204:207], v[24:27]
    s_add_u32 s68, s69, 6144
    buffer_load_dwordx4 v[156:159], v6, s[28:31], s68 offen sc1
    v_mfma_f32_16x16x32_bf16 v[28:31], v[124:127], v[208:211], v[28:31]
    v_mfma_f32_16x16x32_bf16 v[32:35], v[128:131], v[208:211], v[32:35]
    v_mfma_f32_16x16x32_bf16 v[36:39], v[132:135], v[208:211], v[36:39]
    v_mfma_f32_16x16x32_bf16 v[40:43], v[136:139], v[208:211], v[40:43]
    s_add_u32 s68, s71, 6144
    buffer_load_dwordx4 v[160:163], v6, s[28:31], s68 offen sc1
    v_mfma_f32_16x16x32_bf16 v[44:47], v[124:127], v[212:215], v[44:47]
    v_mfma_f32_16x16x32_bf16 v[48:51], v[128:131], v[212:215], v[48:51]
    v_mfma_f32_16x16x32_bf16 v[52:55], v[132:135], v[212:215], v[52:55]
    v_mfma_f32_16x16x32_bf16 v[56:59], v[136:139], v[212:215], v[56:59]
    s_add_u32 s68, s65, 6144
    buffer_load_dwordx4 v[164:167], v6, s[28:31], s68 offen sc1
    v_mfma_f32_16x16x32_bf16 v[60:63], v[124:127], v[216:219], v[60:63]
    v_mfma_f32_16x16x32_bf16 v[64:67], v[128:131], v[216:219], v[64:67]
    v_mfma_f32_16x16x32_bf16 v[68:71], v[132:135], v[216:219], v[68:71]
    v_mfma_f32_16x16x32_bf16 v[72:75], v[136:139], v[216:219], v[72:75]
    s_add_u32 s68, s64, 6144
    buffer_load_dwordx4 v[168:171], v6, s[28:31], s68 offen sc1
    s_waitcnt vmcnt(8)
    s_waitcnt lgkmcnt(0)
    v_mfma_f32_16x16x32_bf16 v[12:15], v[140:143], v[220:223], v[12:15]
    ds_read_b64_tr_b16 v[76:77], v2 offset:0
    v_mfma_f32_16x16x32_bf16 v[16:19], v[144:147], v[220:223], v[16:19]
    ds_read_b64_tr_b16 v[78:79], v2 offset:2048
    v_mfma_f32_16x16x32_bf16 v[20:23], v[148:151], v[220:223], v[20:23]
    ds_read_b64_tr_b16 v[80:81], v3 offset:0
    v_mfma_f32_16x16x32_bf16 v[24:27], v[152:155], v[220:223], v[24:27]
    ds_read_b64_tr_b16 v[82:83], v3 offset:2048
    s_add_u32 s68, s69, 7168
    buffer_load_dwordx4 v[172:175], v6, s[28:31], s68 offen sc1
    v_mfma_f32_16x16x32_bf16 v[28:31], v[140:143], v[224:227], v[28:31]
    ds_read_b64_tr_b16 v[84:85], v4 offset:0
    v_mfma_f32_16x16x32_bf16 v[32:35], v[144:147], v[224:227], v[32:35]
    ds_read_b64_tr_b16 v[86:87], v4 offset:2048
    v_mfma_f32_16x16x32_bf16 v[36:39], v[148:151], v[224:227], v[36:39]
    ds_read_b64_tr_b16 v[88:89], v5 offset:0
    v_mfma_f32_16x16x32_bf16 v[40:43], v[152:155], v[224:227], v[40:43]
    ds_read_b64_tr_b16 v[90:91], v5 offset:2048
    s_add_u32 s68, s71, 7168
    buffer_load_dwordx4 v[176:179], v6, s[28:31], s68 offen sc1
    v_mfma_f32_16x16x32_bf16 v[44:47], v[140:143], v[228:231], v[44:47]
    v_mfma_f32_16x16x32_bf16 v[48:51], v[144:147], v[228:231], v[48:51]
    v_mfma_f32_16x16x32_bf16 v[52:55], v[148:151], v[228:231], v[52:55]
    v_mfma_f32_16x16x32_bf16 v[56:59], v[152:155], v[228:231], v[56:59]
    s_add_u32 s68, s65, 7168
    buffer_load_dwordx4 v[180:183], v6, s[28:31], s68 offen sc1
    v_mfma_f32_16x16x32_bf16 v[60:63], v[140:143], v[232:235], v[60:63]
    v_mfma_f32_16x16x32_bf16 v[64:67], v[144:147], v[232:235], v[64:67]
    v_mfma_f32_16x16x32_bf16 v[68:71], v[148:151], v[232:235], v[68:71]
    v_mfma_f32_16x16x32_bf16 v[72:75], v[152:155], v[232:235], v[72:75]
    s_add_u32 s68, s64, 7168
    buffer_load_dwordx4 v[184:187], v6, s[28:31], s68 offen sc1
    s_waitcnt vmcnt(8)
    s_waitcnt lgkmcnt(0)
    v_mfma_f32_16x16x32_bf16 v[12:15], v[76:79], v[236:239], v[12:15]
    ds_read_b64_tr_b16 v[92:93], v2 offset:4096
    v_mfma_f32_16x16x32_bf16 v[16:19], v[80:83], v[236:239], v[16:19]
    ds_read_b64_tr_b16 v[94:95], v2 offset:6144
    v_mfma_f32_16x16x32_bf16 v[20:23], v[84:87], v[236:239], v[20:23]
    ds_read_b64_tr_b16 v[96:97], v3 offset:4096
    v_mfma_f32_16x16x32_bf16 v[24:27], v[88:91], v[236:239], v[24:27]
    ds_read_b64_tr_b16 v[98:99], v3 offset:6144
    s_add_u32 s68, s69, 8192
    buffer_load_dwordx4 v[188:191], v6, s[28:31], s68 offen sc1
    s_add_u32 s94, s66, 10
    s_lshl_b32 s94, s94, 15
    s_add_u32 m0, s67, 0
    s_nop 0
    buffer_load_dwordx4 v1, s[32:35], s94 offen lds
    v_mfma_f32_16x16x32_bf16 v[28:31], v[76:79], v[240:243], v[28:31]
    ds_read_b64_tr_b16 v[100:101], v4 offset:4096
    v_mfma_f32_16x16x32_bf16 v[32:35], v[80:83], v[240:243], v[32:35]
    ds_read_b64_tr_b16 v[102:103], v4 offset:6144
    v_mfma_f32_16x16x32_bf16 v[36:39], v[84:87], v[240:243], v[36:39]
    ds_read_b64_tr_b16 v[104:105], v5 offset:4096
    v_mfma_f32_16x16x32_bf16 v[40:43], v[88:91], v[240:243], v[40:43]
    ds_read_b64_tr_b16 v[106:107], v5 offset:6144
    s_add_u32 s68, s71, 8192
    buffer_load_dwordx4 v[192:195], v6, s[28:31], s68 offen sc1
    s_add_u32 s94, s94, 8192
    s_add_u32 m0, s67, 1024
    s_nop 0
    buffer_load_dwordx4 v1, s[32:35], s94 offen lds
    v_mfma_f32_16x16x32_bf16 v[44:47], v[76:79], v[244:247], v[44:47]
    v_mfma_f32_16x16x32_bf16 v[48:51], v[80:83], v[244:247], v[48:51]
    v_mfma_f32_16x16x32_bf16 v[52:55], v[84:87], v[244:247], v[52:55]
    v_mfma_f32_16x16x32_bf16 v[56:59], v[88:91], v[244:247], v[56:59]
    s_add_u32 s68, s65, 8192
    buffer_load_dwordx4 v[196:199], v6, s[28:31], s68 offen sc1
    s_add_u32 s94, s94, 8192
    s_add_u32 m0, s67, 2048
    s_nop 0
    buffer_load_dwordx4 v1, s[32:35], s94 offen lds
    v_mfma_f32_16x16x32_bf16 v[60:63], v[76:79], v[248:251], v[60:63]
    v_mfma_f32_16x16x32_bf16 v[64:67], v[80:83], v[248:251], v[64:67]
    v_mfma_f32_16x16x32_bf16 v[68:71], v[84:87], v[248:251], v[68:71]
    v_mfma_f32_16x16x32_bf16 v[72:75], v[88:91], v[248:251], v[72:75]
    s_add_u32 s68, s64, 8192
    buffer_load_dwordx4 v[200:203], v6, s[28:31], s68 offen sc1
    s_add_u32 s94, s94, 8192
    s_add_u32 m0, s67, 3072
    s_nop 0
    buffer_load_dwordx4 v1, s[32:35], s94 offen lds
    s_waitcnt vmcnt(12)
    s_waitcnt lgkmcnt(0)
    v_mfma_f32_16x16x32_bf16 v[12:15], v[92:95], v[156:159], v[12:15]
    ds_read_b64_tr_b16 v[108:109], v2 offset:8192
    v_mfma_f32_16x16x32_bf16 v[16:19], v[96:99], v[156:159], v[16:19]
    ds_read_b64_tr_b16 v[110:111], v2 offset:10240
    v_mfma_f32_16x16x32_bf16 v[20:23], v[100:103], v[156:159], v[20:23]
    ds_read_b64_tr_b16 v[112:113], v3 offset:8192
    v_mfma_f32_16x16x32_bf16 v[24:27], v[104:107], v[156:159], v[24:27]
    ds_read_b64_tr_b16 v[114:115], v3 offset:10240
    s_add_u32 s68, s69, 9216
    buffer_load_dwordx4 v[204:207], v6, s[28:31], s68 offen sc1
    v_mfma_f32_16x16x32_bf16 v[28:31], v[92:95], v[160:163], v[28:31]
    ds_read_b64_tr_b16 v[116:117], v4 offset:8192
    v_mfma_f32_16x16x32_bf16 v[32:35], v[96:99], v[160:163], v[32:35]
    ds_read_b64_tr_b16 v[118:119], v4 offset:10240
    v_mfma_f32_16x16x32_bf16 v[36:39], v[100:103], v[160:163], v[36:39]
    ds_read_b64_tr_b16 v[120:121], v5 offset:8192
    v_mfma_f32_16x16x32_bf16 v[40:43], v[104:107], v[160:163], v[40:43]
    ds_read_b64_tr_b16 v[122:123], v5 offset:10240
    s_add_u32 s68, s71, 9216
    buffer_load_dwordx4 v[208:211], v6, s[28:31], s68 offen sc1
    v_mfma_f32_16x16x32_bf16 v[44:47], v[92:95], v[164:167], v[44:47]
    v_mfma_f32_16x16x32_bf16 v[48:51], v[96:99], v[164:167], v[48:51]
    v_mfma_f32_16x16x32_bf16 v[52:55], v[100:103], v[164:167], v[52:55]
    v_mfma_f32_16x16x32_bf16 v[56:59], v[104:107], v[164:167], v[56:59]
    s_add_u32 s68, s65, 9216
    buffer_load_dwordx4 v[212:215], v6, s[28:31], s68 offen sc1
    v_mfma_f32_16x16x32_bf16 v[60:63], v[92:95], v[168:171], v[60:63]
    v_mfma_f32_16x16x32_bf16 v[64:67], v[96:99], v[168:171], v[64:67]
    v_mfma_f32_16x16x32_bf16 v[68:71], v[100:103], v[168:171], v[68:71]
    v_mfma_f32_16x16x32_bf16 v[72:75], v[104:107], v[168:171], v[72:75]
    s_add_u32 s68, s64, 9216
    buffer_load_dwordx4 v[216:219], v6, s[28:31], s68 offen sc1
    s_waitcnt vmcnt(12)
    s_waitcnt lgkmcnt(0)
    v_mfma_f32_16x16x32_bf16 v[12:15], v[108:111], v[172:175], v[12:15]
    ds_read_b64_tr_b16 v[124:125], v2 offset:12288
    v_mfma_f32_16x16x32_bf16 v[16:19], v[112:115], v[172:175], v[16:19]
    ds_read_b64_tr_b16 v[126:127], v2 offset:14336
    v_mfma_f32_16x16x32_bf16 v[20:23], v[116:119], v[172:175], v[20:23]
    ds_read_b64_tr_b16 v[128:129], v3 offset:12288
    v_mfma_f32_16x16x32_bf16 v[24:27], v[120:123], v[172:175], v[24:27]
    ds_read_b64_tr_b16 v[130:131], v3 offset:14336
    s_add_u32 s68, s69, 10240
    buffer_load_dwordx4 v[220:223], v6, s[28:31], s68 offen sc1
    v_mfma_f32_16x16x32_bf16 v[28:31], v[108:111], v[176:179], v[28:31]
    ds_read_b64_tr_b16 v[132:133], v4 offset:12288
    v_mfma_f32_16x16x32_bf16 v[32:35], v[112:115], v[176:179], v[32:35]
    ds_read_b64_tr_b16 v[134:135], v4 offset:14336
    v_mfma_f32_16x16x32_bf16 v[36:39], v[116:119], v[176:179], v[36:39]
    ds_read_b64_tr_b16 v[136:137], v5 offset:12288
    v_mfma_f32_16x16x32_bf16 v[40:43], v[120:123], v[176:179], v[40:43]
    ds_read_b64_tr_b16 v[138:139], v5 offset:14336
    s_add_u32 s68, s71, 10240
    buffer_load_dwordx4 v[224:227], v6, s[28:31], s68 offen sc1
    v_mfma_f32_16x16x32_bf16 v[44:47], v[108:111], v[180:183], v[44:47]
    v_mfma_f32_16x16x32_bf16 v[48:51], v[112:115], v[180:183], v[48:51]
    v_mfma_f32_16x16x32_bf16 v[52:55], v[116:119], v[180:183], v[52:55]
    v_mfma_f32_16x16x32_bf16 v[56:59], v[120:123], v[180:183], v[56:59]
    s_add_u32 s68, s65, 10240
    buffer_load_dwordx4 v[228:231], v6, s[28:31], s68 offen sc1
    v_mfma_f32_16x16x32_bf16 v[60:63], v[108:111], v[184:187], v[60:63]
    v_mfma_f32_16x16x32_bf16 v[64:67], v[112:115], v[184:187], v[64:67]
    v_mfma_f32_16x16x32_bf16 v[68:71], v[116:119], v[184:187], v[68:71]
    v_mfma_f32_16x16x32_bf16 v[72:75], v[120:123], v[184:187], v[72:75]
    s_add_u32 s68, s64, 10240
    buffer_load_dwordx4 v[232:235], v6, s[28:31], s68 offen sc1
    s_waitcnt vmcnt(9)
    s_waitcnt lgkmcnt(0)
    v_mfma_f32_16x16x32_bf16 v[12:15], v[124:127], v[188:191], v[12:15]
    ds_read_b64_tr_b16 v[140:141], v2 offset:16384
    v_mfma_f32_16x16x32_bf16 v[16:19], v[128:131], v[188:191], v[16:19]
    ds_read_b64_tr_b16 v[142:143], v2 offset:18432
    v_mfma_f32_16x16x32_bf16 v[20:23], v[132:135], v[188:191], v[20:23]
    ds_read_b64_tr_b16 v[144:145], v3 offset:16384
    v_mfma_f32_16x16x32_bf16 v[24:27], v[136:139], v[188:191], v[24:27]
    ds_read_b64_tr_b16 v[146:147], v3 offset:18432
    v_mfma_f32_16x16x32_bf16 v[28:31], v[124:127], v[192:195], v[28:31]
    ds_read_b64_tr_b16 v[148:149], v4 offset:16384
    v_mfma_f32_16x16x32_bf16 v[32:35], v[128:131], v[192:195], v[32:35]
    ds_read_b64_tr_b16 v[150:151], v4 offset:18432
    v_mfma_f32_16x16x32_bf16 v[36:39], v[132:135], v[192:195], v[36:39]
    ds_read_b64_tr_b16 v[152:153], v5 offset:16384
    v_mfma_f32_16x16x32_bf16 v[40:43], v[136:139], v[192:195], v[40:43]
    ds_read_b64_tr_b16 v[154:155], v5 offset:18432
    v_mfma_f32_16x16x32_bf16 v[44:47], v[124:127], v[196:199], v[44:47]
    v_mfma_f32_16x16x32_bf16 v[48:51], v[128:131], v[196:199], v[48:51]
    v_mfma_f32_16x16x32_bf16 v[52:55], v[132:135], v[196:199], v[52:55]
    v_mfma_f32_16x16x32_bf16 v[56:59], v[136:139], v[196:199], v[56:59]
    v_mfma_f32_16x16x32_bf16 v[60:63], v[124:127], v[200:203], v[60:63]
    v_mfma_f32_16x16x32_bf16 v[64:67], v[128:131], v[200:203], v[64:67]
    v_mfma_f32_16x16x32_bf16 v[68:71], v[132:135], v[200:203], v[68:71]
    v_mfma_f32_16x16x32_bf16 v[72:75], v[136:139], v[200:203], v[72:75]
    v_and_b32 v8, 31, v0
    v_mul_u32_u24 v8, 16, v8
    s_lshl_b32 s59, s56, 7
    s_lshr_b32 s58, s55, 3
    s_add_u32 s59, s59, s58
    s_mul_i32 s59, s59, 4
    s_add_u32 s59, s59, 720896
    buffer_load_dword v9, v8, s[48:51], s59 offen sc1
    s_waitcnt vmcnt(5)
    s_waitcnt lgkmcnt(0)
    v_mfma_f32_16x16x32_bf16 v[12:15], v[140:143], v[204:207], v[12:15]
    ds_read_b64_tr_b16 v[76:77], v2 offset:0
    v_mfma_f32_16x16x32_bf16 v[16:19], v[144:147], v[204:207], v[16:19]
    ds_read_b64_tr_b16 v[78:79], v2 offset:2048
    v_mfma_f32_16x16x32_bf16 v[20:23], v[148:151], v[204:207], v[20:23]
    ds_read_b64_tr_b16 v[80:81], v3 offset:0
    v_mfma_f32_16x16x32_bf16 v[24:27], v[152:155], v[204:207], v[24:27]
    ds_read_b64_tr_b16 v[82:83], v3 offset:2048
    v_mfma_f32_16x16x32_bf16 v[28:31], v[140:143], v[208:211], v[28:31]
    ds_read_b64_tr_b16 v[84:85], v4 offset:0
    v_mfma_f32_16x16x32_bf16 v[32:35], v[144:147], v[208:211], v[32:35]
    ds_read_b64_tr_b16 v[86:87], v4 offset:2048
    v_mfma_f32_16x16x32_bf16 v[36:39], v[148:151], v[208:211], v[36:39]
    ds_read_b64_tr_b16 v[88:89], v5 offset:0
    v_mfma_f32_16x16x32_bf16 v[40:43], v[152:155], v[208:211], v[40:43]
    ds_read_b64_tr_b16 v[90:91], v5 offset:2048
    v_mfma_f32_16x16x32_bf16 v[44:47], v[140:143], v[212:215], v[44:47]
    v_mfma_f32_16x16x32_bf16 v[48:51], v[144:147], v[212:215], v[48:51]
    v_mfma_f32_16x16x32_bf16 v[52:55], v[148:151], v[212:215], v[52:55]
    v_mfma_f32_16x16x32_bf16 v[56:59], v[152:155], v[212:215], v[56:59]
    v_mfma_f32_16x16x32_bf16 v[60:63], v[140:143], v[216:219], v[60:63]
    v_mfma_f32_16x16x32_bf16 v[64:67], v[144:147], v[216:219], v[64:67]
    v_mfma_f32_16x16x32_bf16 v[68:71], v[148:151], v[216:219], v[68:71]
    v_mfma_f32_16x16x32_bf16 v[72:75], v[152:155], v[216:219], v[72:75]
    s_waitcnt vmcnt(0)
    s_mov_b32 s60, 2000
POLL_20:
    v_cmp_ne_u32 vcc, s62, v9
    s_cbranch_vccz POLLD_21
    s_sub_u32 s60, s60, 1
    s_cmp_eq_u32 s60, 0
    s_cbranch_scc1 POLLD_21
    buffer_load_dword v9, v8, s[48:51], s59 offen sc1
    s_waitcnt vmcnt(0)
    s_branch POLL_20
POLLD_21:
    s_add_u32 s68, s70, 0
    buffer_load_dword v236, v10, s[40:43], s68 offen sc1
    s_add_u32 s68, s70, 8192
    buffer_load_dword v237, v10, s[40:43], s68 offen sc1
    s_add_u32 s68, s70, 65536
    buffer_load_dword v238, v10, s[40:43], s68 offen sc1
    s_add_u32 s68, s70, 73728
    buffer_load_dword v239, v10, s[40:43], s68 offen sc1
    s_add_u32 s68, s70, 131072
    buffer_load_dword v240, v10, s[40:43], s68 offen sc1
    s_add_u32 s68, s70, 139264
    buffer_load_dword v241, v10, s[40:43], s68 offen sc1
    s_add_u32 s68, s70, 196608
    buffer_load_dword v242, v10, s[40:43], s68 offen sc1
    s_add_u32 s68, s70, 204800
    buffer_load_dword v243, v10, s[40:43], s68 offen sc1
    s_waitcnt lgkmcnt(0)
    v_mfma_f32_16x16x32_bf16 v[28:31], v[76:79], v[224:227], v[28:31]
    v_mfma_f32_16x16x32_bf16 v[32:35], v[80:83], v[224:227], v[32:35]
    v_mfma_f32_16x16x32_bf16 v[36:39], v[84:87], v[224:227], v[36:39]
    v_mfma_f32_16x16x32_bf16 v[40:43], v[88:91], v[224:227], v[40:43]
    v_mfma_f32_16x16x32_bf16 v[44:47], v[76:79], v[228:231], v[44:47]
    v_mfma_f32_16x16x32_bf16 v[48:51], v[80:83], v[228:231], v[48:51]
    v_mfma_f32_16x16x32_bf16 v[52:55], v[84:87], v[228:231], v[52:55]
    v_mfma_f32_16x16x32_bf16 v[56:59], v[88:91], v[228:231], v[56:59]
    v_mfma_f32_16x16x32_bf16 v[60:63], v[76:79], v[232:235], v[60:63]
    v_mfma_f32_16x16x32_bf16 v[64:67], v[80:83], v[232:235], v[64:67]
    v_mfma_f32_16x16x32_bf16 v[68:71], v[84:87], v[232:235], v[68:71]
    v_mfma_f32_16x16x32_bf16 v[72:75], v[88:91], v[232:235], v[72:75]
    v_mfma_f32_16x16x32_bf16 v[12:15], v[76:79], v[220:223], v[12:15]
    v_mfma_f32_16x16x32_bf16 v[16:19], v[80:83], v[220:223], v[16:19]
    v_mfma_f32_16x16x32_bf16 v[20:23], v[84:87], v[220:223], v[20:23]
    v_mfma_f32_16x16x32_bf16 v[24:27], v[88:91], v[220:223], v[24:27]
    ds_write_b128 v252, v[28:31] offset:0
    ds_write_b128 v252, v[32:35] offset:1024
    ds_write_b128 v252, v[36:39] offset:2048
    ds_write_b128 v252, v[40:43] offset:3072
    ds_write_b128 v252, v[44:47] offset:4096
    ds_write_b128 v252, v[48:51] offset:5120
    ds_write_b128 v252, v[52:55] offset:6144
    ds_write_b128 v252, v[56:59] offset:7168
    ds_write_b128 v252, v[60:63] offset:8192
    ds_write_b128 v252, v[64:67] offset:9216
    ds_write_b128 v252, v[68:71] offset:10240
    ds_write_b128 v252, v[72:75] offset:11264
    s_sub_u32 s58, s52, 1
    s_and_b32 s58, s58, 3
    s_mul_i32 s58, s58, 20480
    v_lshl_add_u32 v205, v0, 4, s58
    s_sub_u32 s58, s52, 2
    s_and_b32 s58, s58, 3
    s_mul_i32 s58, s58, 20480
    v_lshl_add_u32 v206, v0, 4, s58
    s_sub_u32 s58, s52, 3
    s_and_b32 s58, s58, 3
    s_mul_i32 s58, s58, 20480
    v_lshl_add_u32 v207, v0, 4, s58
    s_waitcnt lgkmcnt(0)
    s_barrier
    ds_read_b128 v[156:159], v205 offset:0
    ds_read_b128 v[160:163], v205 offset:1024
    ds_read_b128 v[164:167], v205 offset:2048
    ds_read_b128 v[168:171], v205 offset:3072
    ds_read_b128 v[172:175], v206 offset:4096
    ds_read_b128 v[176:179], v206 offset:5120
    ds_read_b128 v[180:183], v206 offset:6144
    ds_read_b128 v[184:187], v206 offset:7168
    ds_read_b128 v[188:191], v207 offset:8192
    ds_read_b128 v[192:195], v207 offset:9216
    ds_read_b128 v[196:199], v207 offset:10240
    ds_read_b128 v[200:203], v207 offset:11264
    s_waitcnt lgkmcnt(8)
    v_pk_add_f32 v[12:13], v[12:13], v[156:157]
    v_pk_add_f32 v[14:15], v[14:15], v[158:159]
    v_pk_add_f32 v[16:17], v[16:17], v[160:161]
    v_pk_add_f32 v[18:19], v[18:19], v[162:163]
    v_pk_add_f32 v[20:21], v[20:21], v[164:165]
    v_pk_add_f32 v[22:23], v[22:23], v[166:167]
    v_pk_add_f32 v[24:25], v[24:25], v[168:169]
    v_pk_add_f32 v[26:27], v[26:27], v[170:171]
    s_waitcnt lgkmcnt(4)
    v_pk_add_f32 v[12:13], v[12:13], v[172:173]
    v_pk_add_f32 v[14:15], v[14:15], v[174:175]
    v_pk_add_f32 v[16:17], v[16:17], v[176:177]
    v_pk_add_f32 v[18:19], v[18:19], v[178:179]
    v_pk_add_f32 v[20:21], v[20:21], v[180:181]
    v_pk_add_f32 v[22:23], v[22:23], v[182:183]
    v_pk_add_f32 v[24:25], v[24:25], v[184:185]
    v_pk_add_f32 v[26:27], v[26:27], v[186:187]
    s_waitcnt lgkmcnt(0)
    v_pk_add_f32 v[12:13], v[12:13], v[188:189]
    v_pk_add_f32 v[14:15], v[14:15], v[190:191]
    v_pk_add_f32 v[16:17], v[16:17], v[192:193]
    v_pk_add_f32 v[18:19], v[18:19], v[194:195]
    v_pk_add_f32 v[20:21], v[20:21], v[196:197]
    v_pk_add_f32 v[22:23], v[22:23], v[198:199]
    v_pk_add_f32 v[24:25], v[24:25], v[200:201]
    v_pk_add_f32 v[26:27], v[26:27], v[202:203]
    s_waitcnt vmcnt(0)
    v_sub_f32 v8, 1.0, v7
    v_cvt_pk_bf16_f32 v8, v8, v8
    v_and_b32 v8, 0xffff0000, v8
    v_mov_b32 v9, v8
    v_lshlrev_b32 v92, 16, v236
    v_and_b32 v93, 0xffff0000, v236
    v_lshlrev_b32 v94, 16, v237
    v_and_b32 v95, 0xffff0000, v237
    v_lshlrev_b32 v96, 16, v238
    v_and_b32 v97, 0xffff0000, v238
    v_lshlrev_b32 v98, 16, v239
    v_and_b32 v99, 0xffff0000, v239
    v_lshlrev_b32 v100, 16, v240
    v_and_b32 v101, 0xffff0000, v240
    v_lshlrev_b32 v102, 16, v241
    v_and_b32 v103, 0xffff0000, v241
    v_lshlrev_b32 v104, 16, v242
    v_and_b32 v105, 0xffff0000, v242
    v_lshlrev_b32 v106, 16, v243
    v_and_b32 v107, 0xffff0000, v243
    v_mul_f32 v92, v7, v92
    v_mul_f32 v93, v7, v93
    v_mul_f32 v94, v7, v94
    v_mul_f32 v95, v7, v95
    v_mul_f32 v96, v7, v96
    v_mul_f32 v97, v7, v97
    v_mul_f32 v98, v7, v98
    v_mul_f32 v99, v7, v99
    v_mul_f32 v100, v7, v100
    v_mul_f32 v101, v7, v101
    v_mul_f32 v102, v7, v102
    v_mul_f32 v103, v7, v103
    v_mul_f32 v104, v7, v104
    v_mul_f32 v105, v7, v105
    v_mul_f32 v106, v7, v106
    v_mul_f32 v107, v7, v107
    v_pk_fma_f32 v[12:13], v[12:13], v[8:9], v[92:93]
    v_pk_fma_f32 v[14:15], v[14:15], v[8:9], v[94:95]
    v_pk_fma_f32 v[16:17], v[16:17], v[8:9], v[96:97]
    v_pk_fma_f32 v[18:19], v[18:19], v[8:9], v[98:99]
    v_pk_fma_f32 v[20:21], v[20:21], v[8:9], v[100:101]
    v_pk_fma_f32 v[22:23], v[22:23], v[8:9], v[102:103]
    v_pk_fma_f32 v[24:25], v[24:25], v[8:9], v[104:105]
    v_pk_fma_f32 v[26:27], v[26:27], v[8:9], v[106:107]
    v_cvt_pk_bf16_f32 v108, v12, v13
    v_cvt_pk_bf16_f32 v109, v14, v15
    v_cvt_pk_bf16_f32 v110, v16, v17
    v_cvt_pk_bf16_f32 v111, v18, v19
    v_cvt_pk_bf16_f32 v112, v20, v21
    v_cvt_pk_bf16_f32 v113, v22, v23
    v_cvt_pk_bf16_f32 v114, v24, v25
    v_cvt_pk_bf16_f32 v115, v26, v27
    s_nop 1
    v_permlane16_swap_b32 v108, v110
    v_permlane16_swap_b32 v109, v111
    v_permlane16_swap_b32 v112, v114
    v_permlane16_swap_b32 v113, v115
    s_nop 1
    ds_bpermute_b32 v116, v255, v108
    ds_bpermute_b32 v117, v255, v109
    ds_bpermute_b32 v118, v255, v110
    ds_bpermute_b32 v119, v255, v111
    ds_bpermute_b32 v120, v255, v112
    ds_bpermute_b32 v121, v255, v113
    ds_bpermute_b32 v122, v255, v114
    ds_bpermute_b32 v123, v255, v115
    s_waitcnt lgkmcnt(4)
    buffer_store_dwordx4 v[116:119], v254, s[44:47], s3 offen offset:0
    s_waitcnt lgkmcnt(0)
    buffer_store_dwordx4 v[120:123], v254, s[44:47], s3 offen offset:64
    s_endpgm
SSM_ROLE:
    s_sub_u32 s2, s2, 256
    s_setprio 1
    s_load_dwordx16 s[4:19], s[0:1], 0
    s_load_dwordx2 s[20:21], s[0:1], 64
    s_load_dwordx2 s[22:23], s[0:1], 120
    s_load_dwordx2 s[50:51], s[0:1], 80
    v_lshrrev_b32 v2, 6, v0
    v_and_b32 v1, 63, v0
    s_lshl_b32 s58, s2, 9
    v_readfirstlane_b32 s40, v2
    v_lshlrev_b32 v10, 1, v0
    v_add_u32 v10, s58, v10
    s_lshl_b32 s59, s2, 2
    v_lshrrev_b32 v11, 7, v0
    v_lshlrev_b32 v11, 1, v11
    v_add_u32 v11, s59, v11
    s_lshr_b32 s41, s40, 1
    s_and_b32 s42, s40, 1
    s_waitcnt lgkmcnt(0)
    s_add_u32 s60, s22, 10551296
    s_addc_u32 s61, s23, 0
    s_load_dword s63, s[60:61], 0
    s_add_u32 s36, s22, 10551296
    s_addc_u32 s37, s23, 0
    s_mov_b32 s38, 0x100000
    s_mov_b32 s39, 0x20000
    s_add_u32 s28, s22, 6291456
    s_addc_u32 s29, s23, 0
    s_mov_b32 s30, 0x200000
    s_mov_b32 s31, 0x20000
    s_mov_b32 s24, s4
    s_mov_b32 s25, s5
    s_mov_b32 s26, 0x200000
    s_mov_b32 s27, 0x20000
    v_lshrrev_b32 v60, 2, v1
    v_lshlrev_b32 v60, 10, v60
    v_and_b32 v61, 3, v1
    v_lshl_add_u32 v60, v61, 4, v60
    s_and_b32 s44, s2, 15
    s_lshl_b32 s44, s44, 7
    s_lshl_b32 s45, s40, 5
    s_add_u32 s44, s44, s45
    s_lshl_b32 s45, s44, 10
    s_lshr_b32 s46, s2, 4
    s_lshl_b32 s47, s46, 6
    s_add_u32 s45, s45, s47
    s_lshl_b32 s47, s40, 11
    s_add_u32 s47, s47, 62016
    s_mov_b32 m0, s47
    s_add_u32 s48, s45, 16384
    buffer_load_dwordx4 v60, s[24:27], s45 offen lds
    s_add_u32 m0, s47, 1024
    s_nop 0
    buffer_load_dwordx4 v60, s[24:27], s48 offen lds
    global_load_ushort v2, v10, s[6:7]
    global_load_ushort v3, v10, s[8:9]
    global_load_ushort v4, v10, s[10:11]
    global_load_ushort v5, v10, s[12:13]
    global_load_ushort v6, v10, s[14:15]
    global_load_ushort v7, v10, s[16:17]
    global_load_ushort v8, v11, s[18:19]
    s_load_dword s43, s[20:21], s59
    v_lshrrev_b32 v61, 4, v1
    v_bfe_u32 v62, v1, 2, 2
    v_lshl_add_u32 v62, v61, 3, v62
    v_lshlrev_b32 v62, 6, v62
    v_and_b32 v63, 3, v1
    v_lshl_add_u32 v62, v63, 3, v62
    v_add_u32 v62, s47, v62
    v_and_b32 v63, 15, v1
    v_lshlrev_b32 v63, 12, v63
    v_lshl_add_u32 v63, v61, 4, v63
    s_lshl_b32 s46, s46, 17
    s_lshl_b32 s44, s44, 1
    s_add_u32 s46, s46, s44
    s_add_u32 s49, s46, 0x10000
    s_waitcnt lgkmcnt(0)
    s_mul_i32 s62, s63, 0x9E3779B1
    s_add_u32 s62, s62, 0x7F4A7C15
    s_waitcnt vmcnt(7)
    ds_read_b64_tr_b16 v[64:65], v62 offset:0
    ds_read_b64_tr_b16 v[66:67], v62 offset:256
    ds_read_b64_tr_b16 v[68:69], v62 offset:32
    ds_read_b64_tr_b16 v[70:71], v62 offset:288
    s_waitcnt lgkmcnt(0)
    buffer_store_dwordx4 v[64:67], v63, s[28:31], s46 offen sc1
    buffer_store_dwordx4 v[68:71], v63, s[28:31], s49 offen sc1
    s_waitcnt vmcnt(2)
    v_lshlrev_b32 v2, 16, v2
    v_lshlrev_b32 v3, 16, v3
    v_lshlrev_b32 v4, 16, v4
    v_lshlrev_b32 v5, 16, v5
    v_lshlrev_b32 v6, 16, v6
    v_lshlrev_b32 v7, 16, v7
    v_lshlrev_b32 v8, 16, v8
    v_mov_b32 v56, 0x3fb8aa3b
    v_mul_f32 v12, v56, v8
    v_fma_f32 v13, v8, v56, -v12
    v_mov_b32 v57, 0x32a57060
    v_fma_f32 v13, v8, v57, v13
    v_exp_f32 v12, v12
    v_mul_f32 v13, 0x3f317218, v13
    s_nop 0
    v_fma_f32 v12, v12, v13, v12
    v_cvt_pk_bf16_f32 v12, v12, v12
    v_and_b32 v12, 0xffff0000, v12
    v_mul_f32 v2, v12, v2
    v_mul_f32 v3, v12, v3
    v_mul_f32 v4, v12, v4
    v_mul_f32 v5, v12, v5
    v_mul_f32 v2, v56, v2
    v_mul_f32 v3, 0.15915494, v3
    v_lshrrev_b32 v10, 7, v0
    v_mul_u32_u24 v10, 31008, v10
    v_and_b32 v11, 0x7f, v0
    v_lshl_add_u32 v10, v11, 2, v10
    v_mul_f32 v52, v6, v4
    v_mul_f32 v53, v6, v5
    v_fma_f32 v48, v7, -v5, v52
    v_fma_f32 v49, v7, v4, v53
    v_mul_f32 v12, 1.0, v2
    v_mul_f32 v13, 1.0, v3
    v_exp_f32 v12, v12
    v_fract_f32 v13, v13
    v_cos_f32 v14, v13
    v_sin_f32 v15, v13
    s_nop 0
    v_mul_f32 v16, v12, v14
    v_mul_f32 v17, v12, v15
    v_mul_f32 v12, 0x41000000, v2
    v_mul_f32 v13, 0x41000000, v3
    v_exp_f32 v12, v12
    v_fract_f32 v13, v13
    v_cos_f32 v14, v13
    v_sin_f32 v15, v13
    s_nop 0
    v_mul_f32 v46, v12, v14
    v_mul_f32 v47, v12, v15
    v_mul_f32 v12, 0x43000000, v2
    v_mul_f32 v13, 0x43000000, v3
    v_exp_f32 v12, v12
    v_fract_f32 v13, v13
    v_cos_f32 v14, v13
    v_sin_f32 v15, v13
    s_nop 0
    v_mul_f32 v30, v12, v14
    v_mul_f32 v31, v12, v15
    v_mov_b32 v12, 0x3f80
    ds_write_b32 v10, v12 offset:22304
    v_cvt_pk_bf16_f32 v56, v48, -v49
    ds_write_b32 v10, v56 offset:0
    v_mul_f32 v54, v48, v46
    v_mul_f32 v55, v48, v47
    v_fma_f32 v50, v49, -v47, v54
    v_fma_f32 v51, v49, v46, v55
    v_mul_f32 v52, v16, v16
    v_mul_f32 v53, v16, v17
    v_fma_f32 v18, v17, -v17, v52
    v_fma_f32 v19, v17, v16, v53
    v_cvt_pk_bf16_f32 v57, v16, v17
    ds_write_b32 v10, v57 offset:22848
    v_cvt_pk_bf16_f32 v58, v50, -v51
    ds_write_b32 v10, v58 offset:544
    v_mul_f32 v54, v50, v46
    v_mul_f32 v55, v50, v47
    v_fma_f32 v48, v51, -v47, v54
    v_fma_f32 v49, v51, v46, v55
    v_mul_f32 v52, v18, v16
    v_mul_f32 v53, v18, v17
    v_fma_f32 v20, v19, -v17, v52
    v_fma_f32 v21, v19, v16, v53
    v_cvt_pk_bf16_f32 v59, v18, v19
    ds_write_b32 v10, v59 offset:23392
    v_cvt_pk_bf16_f32 v56, v48, -v49
    ds_write_b32 v10, v56 offset:1088
    v_mul_f32 v54, v48, v46
    v_mul_f32 v55, v48, v47
    v_fma_f32 v50, v49, -v47, v54
    v_fma_f32 v51, v49, v46, v55
    v_mul_f32 v52, v18, v18
    v_mul_f32 v53, v18, v19
    v_fma_f32 v22, v19, -v19, v52
    v_fma_f32 v23, v19, v18, v53
    v_cvt_pk_bf16_f32 v57, v20, v21
    ds_write_b32 v10, v57 offset:23936
    v_cvt_pk_bf16_f32 v58, v50, -v51
    ds_write_b32 v10, v58 offset:1632
    v_mul_f32 v54, v50, v46
    v_mul_f32 v55, v50, v47
    v_fma_f32 v48, v51, -v47, v54
    v_fma_f32 v49, v51, v46, v55
    v_mul_f32 v52, v22, v16
    v_mul_f32 v53, v22, v17
    v_fma_f32 v24, v23, -v17, v52
    v_fma_f32 v25, v23, v16, v53
    v_cvt_pk_bf16_f32 v59, v22, v23
    ds_write_b32 v10, v59 offset:26656
    v_mul_f32 v52, v20, v20
    v_mul_f32 v53, v20, v21
    v_fma_f32 v26, v21, -v21, v52
    v_fma_f32 v27, v21, v20, v53
    v_cvt_pk_bf16_f32 v56, v24, v25
    ds_write_b32 v10, v56 offset:27200
    v_cvt_pk_bf16_f32 v57, v48, -v49
    ds_write_b32 v10, v57 offset:2176
    v_mul_f32 v54, v48, v46
    v_mul_f32 v55, v48, v47
    v_fma_f32 v50, v49, -v47, v54
    v_fma_f32 v51, v49, v46, v55
    v_mul_f32 v52, v22, v20
    v_mul_f32 v53, v22, v21
    v_fma_f32 v28, v23, -v21, v52
    v_fma_f32 v29, v23, v20, v53
    v_cvt_pk_bf16_f32 v58, v26, v27
    ds_write_b32 v10, v58 offset:27744
    v_mul_f32 v52, v30, v30
    v_mul_f32 v53, v30, v31
    v_fma_f32 v32, v31, -v31, v52
    v_fma_f32 v33, v31, v30, v53
    v_cvt_pk_bf16_f32 v59, v28, v29
    ds_write_b32 v10, v59 offset:28288
    v_cvt_pk_bf16_f32 v56, v50, -v51
    ds_write_b32 v10, v56 offset:2720
    v_mul_f32 v54, v50, v46
    v_mul_f32 v55, v50, v47
    v_fma_f32 v48, v51, -v47, v54
    v_fma_f32 v49, v51, v46, v55
    v_cvt_pk_bf16_f32 v57, v30, v31
    ds_write_b32 v10, v57 offset:24480
    v_mul_f32 v52, v30, v16
    v_mul_f32 v53, v30, v17
    v_fma_f32 v12, v31, -v17, v52
    v_fma_f32 v13, v31, v16, v53
    v_cvt_pk_bf16_f32 v58, v12, v13
    ds_write_b32 v10, v58 offset:25024
    v_mul_f32 v52, v30, v18
    v_mul_f32 v53, v30, v19
    v_fma_f32 v12, v31, -v19, v52
    v_fma_f32 v13, v31, v18, v53
    v_cvt_pk_bf16_f32 v59, v12, v13
    ds_write_b32 v10, v59 offset:25568
    v_mul_f32 v52, v30, v20
    v_mul_f32 v53, v30, v21
    v_fma_f32 v12, v31, -v21, v52
    v_fma_f32 v13, v31, v20, v53
    v_cvt_pk_bf16_f32 v56, v12, v13
    ds_write_b32 v10, v56 offset:26112
    v_cvt_pk_bf16_f32 v57, v48, -v49
    ds_write_b32 v10, v57 offset:3264
    v_mul_f32 v54, v48, v46
    v_mul_f32 v55, v48, v47
    v_fma_f32 v50, v49, -v47, v54
    v_fma_f32 v51, v49, v46, v55
    v_mul_f32 v52, v30, v22
    v_mul_f32 v53, v30, v23
    v_fma_f32 v12, v31, -v23, v52
    v_fma_f32 v13, v31, v22, v53
    v_cvt_pk_bf16_f32 v58, v12, v13
    ds_write_b32 v10, v58 offset:28832
    v_mul_f32 v52, v30, v24
    v_mul_f32 v53, v30, v25
    v_fma_f32 v12, v31, -v25, v52
    v_fma_f32 v13, v31, v24, v53
    v_cvt_pk_bf16_f32 v59, v12, v13
    ds_write_b32 v10, v59 offset:29376
    v_mul_f32 v52, v30, v26
    v_mul_f32 v53, v30, v27
    v_fma_f32 v12, v31, -v27, v52
    v_fma_f32 v13, v31, v26, v53
    v_cvt_pk_bf16_f32 v56, v12, v13
    ds_write_b32 v10, v56 offset:29920
    v_mul_f32 v52, v30, v28
    v_mul_f32 v53, v30, v29
    v_fma_f32 v12, v31, -v29, v52
    v_fma_f32 v13, v31, v28, v53
    v_cvt_pk_bf16_f32 v57, v12, v13
    ds_write_b32 v10, v57 offset:30464
    v_cvt_pk_bf16_f32 v58, v50, -v51
    ds_write_b32 v10, v58 offset:3808
    v_mul_f32 v54, v50, v46
    v_mul_f32 v55, v50, v47
    v_fma_f32 v48, v51, -v47, v54
    v_fma_f32 v49, v51, v46, v55
    v_mul_f32 v52, v32, v30
    v_mul_f32 v53, v32, v31
    v_fma_f32 v34, v33, -v31, v52
    v_fma_f32 v35, v33, v30, v53
    v_cvt_pk_bf16_f32 v59, v32, v33
    ds_write_b32 v10, v59 offset:17952
    v_mul_f32 v52, v32, v18
    v_mul_f32 v53, v32, v19
    v_fma_f32 v12, v33, -v19, v52
    v_fma_f32 v13, v33, v18, v53
    v_cvt_pk_bf16_f32 v56, v12, v13
    ds_write_b32 v10, v56 offset:18496
    v_mul_f32 v52, v32, v22
    v_mul_f32 v53, v32, v23
    v_fma_f32 v12, v33, -v23, v52
    v_fma_f32 v13, v33, v22, v53
    v_cvt_pk_bf16_f32 v57, v12, v13
    ds_write_b32 v10, v57 offset:19040
    v_mul_f32 v52, v32, v26
    v_mul_f32 v53, v32, v27
    v_fma_f32 v12, v33, -v27, v52
    v_fma_f32 v13, v33, v26, v53
    v_cvt_pk_bf16_f32 v58, v12, v13
    ds_write_b32 v10, v58 offset:19584
    v_cvt_pk_bf16_f32 v59, v48, -v49
    ds_write_b32 v10, v59 offset:4352
    v_mul_f32 v54, v48, v46
    v_mul_f32 v55, v48, v47
    v_fma_f32 v50, v49, -v47, v54
    v_fma_f32 v51, v49, v46, v55
    v_mul_f32 v52, v32, v32
    v_mul_f32 v53, v32, v33
    v_fma_f32 v36, v33, -v33, v52
    v_fma_f32 v37, v33, v32, v53
    v_cvt_pk_bf16_f32 v56, v34, v35
    ds_write_b32 v10, v56 offset:20128
    v_mul_f32 v52, v34, v18
    v_mul_f32 v53, v34, v19
    v_fma_f32 v12, v35, -v19, v52
    v_fma_f32 v13, v35, v18, v53
    v_cvt_pk_bf16_f32 v57, v12, v13
    ds_write_b32 v10, v57 offset:20672
    v_mul_f32 v52, v34, v22
    v_mul_f32 v53, v34, v23
    v_fma_f32 v12, v35, -v23, v52
    v_fma_f32 v13, v35, v22, v53
    v_cvt_pk_bf16_f32 v58, v12, v13
    ds_write_b32 v10, v58 offset:21216
    v_mul_f32 v52, v34, v26
    v_mul_f32 v53, v34, v27
    v_fma_f32 v12, v35, -v27, v52
    v_fma_f32 v13, v35, v26, v53
    v_cvt_pk_bf16_f32 v59, v12, v13
    ds_write_b32 v10, v59 offset:21760
    v_cvt_pk_bf16_f32 v56, v50, -v51
    ds_write_b32 v10, v56 offset:4896
    v_mul_f32 v54, v50, v46
    v_mul_f32 v55, v50, v47
    v_fma_f32 v48, v51, -v47, v54
    v_fma_f32 v49, v51, v46, v55
    s_waitcnt vmcnt(0)
    s_lshl_b32 s58, s2, 2
    s_add_u32 s58, s58, s40
    s_mul_i32 s58, s58, 4
    s_add_u32 s58, s58, 196608
    v_mov_b32 v254, s62
    v_mov_b32 v255, 0
    s_mov_b64 exec, 1
    buffer_store_dword v254, v255, s[36:39], s58 offen sc1
    s_mov_b64 exec, -1
    v_mul_f32 v52, v36, v30
    v_mul_f32 v53, v36, v31
    v_fma_f32 v38, v37, -v31, v52
    v_fma_f32 v39, v37, v30, v53
    v_cvt_pk_bf16_f32 v57, v36, v37
    ds_write_b32 v10, v57 offset:10336
    v_mul_f32 v52, v34, v34
    v_mul_f32 v53, v34, v35
    v_fma_f32 v40, v35, -v35, v52
    v_fma_f32 v41, v35, v34, v53
    v_cvt_pk_bf16_f32 v58, v38, v39
    ds_write_b32 v10, v58 offset:12512
    v_cvt_pk_bf16_f32 v59, v48, -v49
    ds_write_b32 v10, v59 offset:5440
    v_mul_f32 v54, v48, v46
    v_mul_f32 v55, v48, v47
    v_fma_f32 v50, v49, -v47, v54
    v_fma_f32 v51, v49, v46, v55
    v_mul_f32 v52, v36, v34
    v_mul_f32 v53, v36, v35
    v_fma_f32 v42, v37, -v35, v52
    v_fma_f32 v43, v37, v34, v53
    v_cvt_pk_bf16_f32 v56, v40, v41
    ds_write_b32 v10, v56 offset:14688
    v_mul_f32 v52, v36, v36
    v_mul_f32 v53, v36, v37
    v_fma_f32 v44, v37, -v37, v52
    v_fma_f32 v45, v37, v36, v53
    v_cvt_pk_bf16_f32 v57, v42, v43
    ds_write_b32 v10, v57 offset:16864
    v_cvt_pk_bf16_f32 v58, v50, -v51
    ds_write_b32 v10, v58 offset:5984
    v_mul_f32 v54, v50, v46
    v_mul_f32 v55, v50, v47
    v_fma_f32 v48, v51, -v47, v54
    v_fma_f32 v49, v51, v46, v55
    v_mul_f32 v52, v36, v22
    v_mul_f32 v53, v36, v23
    v_fma_f32 v12, v37, -v23, v52
    v_fma_f32 v13, v37, v22, v53
    v_cvt_pk_bf16_f32 v59, v12, v13
    ds_write_b32 v10, v59 offset:10880
    v_mul_f32 v52, v38, v22
    v_mul_f32 v53, v38, v23
    v_fma_f32 v12, v39, -v23, v52
    v_fma_f32 v13, v39, v22, v53
    v_cvt_pk_bf16_f32 v56, v12, v13
    ds_write_b32 v10, v56 offset:13056
    v_mul_f32 v52, v40, v22
    v_mul_f32 v53, v40, v23
    v_fma_f32 v12, v41, -v23, v52
    v_fma_f32 v13, v41, v22, v53
    v_cvt_pk_bf16_f32 v57, v12, v13
    ds_write_b32 v10, v57 offset:15232
    v_mul_f32 v52, v42, v22
    v_mul_f32 v53, v42, v23
    v_fma_f32 v12, v43, -v23, v52
    v_fma_f32 v13, v43, v22, v53
    v_cvt_pk_bf16_f32 v58, v12, v13
    ds_write_b32 v10, v58 offset:17408
    v_cvt_pk_bf16_f32 v59, v48, -v49
    ds_write_b32 v10, v59 offset:6528
    v_mul_f32 v54, v48, v46
    v_mul_f32 v55, v48, v47
    v_fma_f32 v50, v49, -v47, v54
    v_fma_f32 v51, v49, v46, v55
    v_cvt_pk_bf16_f32 v56, v44, v45
    ds_write_b32 v10, v56 offset:9248
    v_mul_f32 v52, v44, v30
    v_mul_f32 v53, v44, v31
    v_fma_f32 v12, v45, -v31, v52
    v_fma_f32 v13, v45, v30, v53
    v_cvt_pk_bf16_f32 v57, v12, v13
    ds_write_b32 v10, v57 offset:11424
    v_mul_f32 v52, v44, v32
    v_mul_f32 v53, v44, v33
    v_fma_f32 v12, v45, -v33, v52
    v_fma_f32 v13, v45, v32, v53
    v_cvt_pk_bf16_f32 v58, v12, v13
    ds_write_b32 v10, v58 offset:13600
    v_mul_f32 v52, v44, v34
    v_mul_f32 v53, v44, v35
    v_fma_f32 v12, v45, -v35, v52
    v_fma_f32 v13, v45, v34, v53
    v_cvt_pk_bf16_f32 v59, v12, v13
    ds_write_b32 v10, v59 offset:15776
    v_cvt_pk_bf16_f32 v56, v50, -v51
    ds_write_b32 v10, v56 offset:7072
    v_mul_f32 v54, v50, v46
    v_mul_f32 v55, v50, v47
    v_fma_f32 v48, v51, -v47, v54
    v_fma_f32 v49, v51, v46, v55
    v_cvt_pk_bf16_f32 v57, v48, -v49
    ds_write_b32 v10, v57 offset:7616
    v_mul_f32 v54, v48, v46
    v_mul_f32 v55, v48, v47
    v_fma_f32 v50, v49, -v47, v54
    v_fma_f32 v51, v49, v46, v55
    v_mul_f32 v52, v44, v36
    v_mul_f32 v53, v44, v37
    v_fma_f32 v12, v45, -v37, v52
    v_fma_f32 v13, v45, v36, v53
    v_cvt_pk_bf16_f32 v58, v12, v13
    ds_write_b32 v10, v58 offset:9792
    v_cvt_pk_bf16_f32 v59, v50, -v51
    ds_write_b32 v10, v59 offset:8160
    v_mul_f32 v54, v50, v46
    v_mul_f32 v55, v50, v47
    v_fma_f32 v48, v51, -v47, v54
    v_fma_f32 v49, v51, v46, v55
    v_mul_f32 v52, v44, v38
    v_mul_f32 v53, v44, v39
    v_fma_f32 v12, v45, -v39, v52
    v_fma_f32 v13, v45, v38, v53
    v_cvt_pk_bf16_f32 v56, v12, v13
    ds_write_b32 v10, v56 offset:11968
    v_cvt_pk_bf16_f32 v57, v48, -v49
    ds_write_b32 v10, v57 offset:8704
    v_mul_f32 v52, v44, v40
    v_mul_f32 v53, v44, v41
    v_fma_f32 v12, v45, -v41, v52
    v_fma_f32 v13, v45, v40, v53
    v_cvt_pk_bf16_f32 v58, v12, v13
    ds_write_b32 v10, v58 offset:14144
    v_mul_f32 v52, v44, v42
    v_mul_f32 v53, v44, v43
    v_fma_f32 v12, v45, -v43, v52
    v_fma_f32 v13, v45, v42, v53
    v_cvt_pk_bf16_f32 v59, v12, v13
    ds_write_b32 v10, v59 offset:16320
    v_and_b32 v15, 15, v1
    v_lshrrev_b32 v16, 4, v1
    v_mul_u32_u24 v12, 544, v15
    v_lshl_add_u32 v12, v16, 4, v12
    s_mul_i32 s44, s41, 31008
    v_add_u32 v12, s44, v12
    s_mul_i32 s45, s42, 8704
    s_add_u32 s45, s45, 9248
    v_add_u32 v13, s45, v12
    v_and_b32 v15, 7, v15
    v_mul_u32_u24 v14, 544, v15
    v_lshl_add_u32 v14, v16, 4, v14
    s_add_u32 s44, s44, 26656
    v_add_u32 v14, s44, v14
    s_waitcnt lgkmcnt(0)
    s_barrier
    ds_read_b128 v[80:83], v13 offset:0
    ds_read_b128 v[84:87], v12 offset:0
    ds_read_b128 v[88:91], v12 offset:544
    ds_read_b128 v[92:95], v14 offset:0
    ds_read_b128 v[96:99], v13 offset:64
    ds_read_b128 v[100:103], v12 offset:64
    ds_read_b128 v[104:107], v12 offset:608
    ds_read_b128 v[108:111], v14 offset:64
    ds_read_b128 v[112:115], v13 offset:128
    ds_read_b128 v[116:119], v12 offset:128
    ds_read_b128 v[120:123], v12 offset:672
    ds_read_b128 v[124:127], v14 offset:128
    s_waitcnt lgkmcnt(8)
    v_mfma_f32_16x16x32_bf16 v[128:131], v[80:83], v[84:87], 0
    v_mfma_f32_16x16x32_bf16 v[132:135], v[80:83], v[88:91], 0
    v_mfma_f32_16x16x32_bf16 v[136:139], v[92:95], v[84:87], 0
    ds_read_b128 v[80:83], v13 offset:192
    ds_read_b128 v[84:87], v12 offset:192
    ds_read_b128 v[88:91], v12 offset:736
    ds_read_b128 v[92:95], v14 offset:192
    s_waitcnt lgkmcnt(8)
    v_mfma_f32_16x16x32_bf16 v[128:131], v[96:99], v[100:103], v[128:131]
    v_mfma_f32_16x16x32_bf16 v[132:135], v[96:99], v[104:107], v[132:135]
    v_mfma_f32_16x16x32_bf16 v[136:139], v[108:111], v[100:103], v[136:139]
    ds_read_b128 v[96:99], v13 offset:256
    ds_read_b128 v[100:103], v12 offset:256
    ds_read_b128 v[104:107], v12 offset:800
    ds_read_b128 v[108:111], v14 offset:256
    s_waitcnt lgkmcnt(8)
    v_mfma_f32_16x16x32_bf16 v[128:131], v[112:115], v[116:119], v[128:131]
    v_mfma_f32_16x16x32_bf16 v[132:135], v[112:115], v[120:123], v[132:135]
    v_mfma_f32_16x16x32_bf16 v[136:139], v[124:127], v[116:119], v[136:139]
    ds_read_b128 v[112:115], v13 offset:320
    ds_read_b128 v[116:119], v12 offset:320
    ds_read_b128 v[120:123], v12 offset:864
    ds_read_b128 v[124:127], v14 offset:320
    s_waitcnt lgkmcnt(8)
    v_mfma_f32_16x16x32_bf16 v[128:131], v[80:83], v[84:87], v[128:131]
    v_mfma_f32_16x16x32_bf16 v[132:135], v[80:83], v[88:91], v[132:135]
    v_mfma_f32_16x16x32_bf16 v[136:139], v[92:95], v[84:87], v[136:139]
    ds_read_b128 v[80:83], v13 offset:384
    ds_read_b128 v[84:87], v12 offset:384
    ds_read_b128 v[88:91], v12 offset:928
    ds_read_b128 v[92:95], v14 offset:384
    s_waitcnt lgkmcnt(8)
    v_mfma_f32_16x16x32_bf16 v[128:131], v[96:99], v[100:103], v[128:131]
    v_mfma_f32_16x16x32_bf16 v[132:135], v[96:99], v[104:107], v[132:135]
    v_mfma_f32_16x16x32_bf16 v[136:139], v[108:111], v[100:103], v[136:139]
    v_mul_u32_u24 v24, 4, v1
    s_lshr_b32 s50, s2, 4
    s_mul_i32 s50, s50, 256
    s_add_u32 s50, s50, 196608
    buffer_load_dword v25, v24, s[36:39], s50 offen sc1
    ds_read_b128 v[96:99], v13 offset:448
    ds_read_b128 v[100:103], v12 offset:448
    ds_read_b128 v[104:107], v12 offset:992
    ds_read_b128 v[108:111], v14 offset:448
    s_waitcnt lgkmcnt(8)
    v_mfma_f32_16x16x32_bf16 v[128:131], v[112:115], v[116:119], v[128:131]
    v_mfma_f32_16x16x32_bf16 v[132:135], v[112:115], v[120:123], v[132:135]
    v_mfma_f32_16x16x32_bf16 v[136:139], v[124:127], v[116:119], v[136:139]
    s_waitcnt lgkmcnt(4)
    v_mfma_f32_16x16x32_bf16 v[128:131], v[80:83], v[84:87], v[128:131]
    v_mfma_f32_16x16x32_bf16 v[132:135], v[80:83], v[88:91], v[132:135]
    v_mfma_f32_16x16x32_bf16 v[136:139], v[92:95], v[84:87], v[136:139]
    s_waitcnt lgkmcnt(0)
    s_barrier
    v_mfma_f32_16x16x32_bf16 v[128:131], v[96:99], v[100:103], v[128:131]
    v_mfma_f32_16x16x32_bf16 v[132:135], v[96:99], v[104:107], v[132:135]
    v_mfma_f32_16x16x32_bf16 v[136:139], v[108:111], v[100:103], v[136:139]
    s_waitcnt vmcnt(0)
    s_mov_b32 s60, 2000
POLL_22:
    v_cmp_ne_u32 vcc, s62, v25
    s_cbranch_vccz POLLD_23
    s_sub_u32 s60, s60, 1
    s_cmp_eq_u32 s60, 0
    s_cbranch_scc1 POLLD_23
    buffer_load_dword v25, v24, s[36:39], s50 offen sc1
    s_waitcnt vmcnt(0)
    s_branch POLL_22
POLLD_23:
    v_lshlrev_b32 v26, 4, v0
    s_lshl_b32 s50, s2, 13
    s_add_u32 s51, s50, 4096
    buffer_load_dwordx4 v[72:75], v26, s[28:31], s50 offen sc1
    buffer_load_dwordx4 v[76:79], v26, s[28:31], s51 offen sc1
    v_and_b32 v16, 31, v0
    v_lshlrev_b32 v16, 4, v16
    v_mov_b32 v20, 0
    v_mov_b32 v21, 0
    v_mov_b32 v22, 0
    v_mov_b32 v23, 0
    ds_write_b128 v16, v[20:23] offset:0
    ds_write_b128 v16, v[20:23] offset:4608
    s_mul_i32 s44, s41, 8320
    s_add_u32 s44, s44, 66128
    s_cmp_eq_u32 s42, 1
    s_cbranch_scc1 KB_24
    s_sub_u32 s44, s44, 3072
    v_lshlrev_b32 v17, 4, v1
    v_sub_u32 v17, s44, v17
    v_and_b32 v18, 1, v1
    v_cmp_eq_u32 vcc, 0, v18
    s_nop 1
    v_cndmask_b32 v18, v132, v128, vcc
    v_cvt_pk_bf16_f32 v140, v132, v132
    v_cvt_pk_bf16_f32 v141, v132, v132
    v_cvt_pk_bf16_f32 v142, v18, v128
    v_cvt_pk_bf16_f32 v143, v128, v128
    v_cvt_pk_bf16_f32 v144, v132, v132
    v_cvt_pk_bf16_f32 v145, v132, v132
    v_cvt_pk_bf16_f32 v146, v132, v18
    v_cvt_pk_bf16_f32 v147, v128, v128
    ds_write_b128 v17, v[140:143] offset:1024
    ds_write_b128 v17, v[144:147] offset:5184
    v_cndmask_b32 v18, v133, v129, vcc
    v_cvt_pk_bf16_f32 v148, v133, v133
    v_cvt_pk_bf16_f32 v149, v133, v133
    v_cvt_pk_bf16_f32 v150, v18, v129
    v_cvt_pk_bf16_f32 v151, v129, v129
    v_cvt_pk_bf16_f32 v152, v133, v133
    v_cvt_pk_bf16_f32 v153, v133, v133
    v_cvt_pk_bf16_f32 v154, v133, v18
    v_cvt_pk_bf16_f32 v155, v129, v129
    ds_write_b128 v17, v[148:151] offset:0
    ds_write_b128 v17, v[152:155] offset:4160
    v_cvt_pk_bf16_f32 v156, v134, v134
    v_cvt_pk_bf16_f32 v157, v134, v131
    v_cvt_pk_bf16_f32 v158, v131, v131
    v_cvt_pk_bf16_f32 v159, v130, v130
    v_cvt_pk_bf16_f32 v160, v134, v134
    v_cvt_pk_bf16_f32 v161, v134, v134
    v_cvt_pk_bf16_f32 v162, v131, v131
    v_cvt_pk_bf16_f32 v163, v131, v130
    ds_write_b128 v17, v[156:159] offset:2048
    ds_write_b128 v17, v[160:163] offset:6208
    s_branch KE_25
KB_24:
    v_xor_b32 v17, 32, v1
    v_lshlrev_b32 v17, 4, v17
    v_sub_u32 v17, s44, v17
    s_mov_b32 exec_hi, 0
    v_cvt_pk_bf16_f32 v140, v132, v132
    v_cvt_pk_bf16_f32 v141, v131, v130
    v_cvt_pk_bf16_f32 v142, v130, v130
    v_cvt_pk_bf16_f32 v143, v129, v128
    v_cvt_pk_bf16_f32 v144, v132, v132
    v_cvt_pk_bf16_f32 v145, v132, v131
    v_cvt_pk_bf16_f32 v146, v130, v130
    v_cvt_pk_bf16_f32 v147, v130, v129
    s_mov_b32 exec_lo, 0
    s_mov_b32 exec_hi, -1
    v_cmp_eq_u32 vcc, 63, v1
    s_nop 1
    v_cndmask_b32 v18, v133, v132, vcc
    v_cvt_pk_bf16_f32 v140, v132, v139
    v_cvt_pk_bf16_f32 v141, v138, v137
    v_cvt_pk_bf16_f32 v142, v136, v131
    v_cvt_pk_bf16_f32 v143, v130, v129
    v_cvt_pk_bf16_f32 v144, v18, v132
    v_cvt_pk_bf16_f32 v145, v139, v138
    v_cvt_pk_bf16_f32 v146, v137, v136
    v_cvt_pk_bf16_f32 v147, v131, v130
    s_mov_b64 exec, -1
    ds_write_b128 v17, v[140:143]
    ds_write_b128 v17, v[144:147] offset:4160
    v_cvt_pk_bf16_f32 v148, v128, v20
    v_mov_b32 v149, 0
    v_mov_b32 v150, 0
    v_mov_b32 v151, 0
    v_cvt_pk_bf16_f32 v152, v129, v128
    v_mov_b32 v153, 0
    v_mov_b32 v154, 0
    v_mov_b32 v155, 0
    v_mov_b32 v19, s44
    s_mov_b32 exec_lo, 0
    s_mov_b32 exec_hi, 1
    ds_write_b128 v19, v[148:151] offset:16
    ds_write_b128 v19, v[152:155] offset:4176
    ds_write_b128 v19, v[20:23] offset:32
    ds_write_b128 v19, v[20:23] offset:4192
    s_mov_b64 exec, -1
KE_25:
    s_waitcnt vmcnt(0)
    v_lshlrev_b32 v15, 4, v0
    ds_write_b128 v15, v[72:75] offset:512
    ds_write_b128 v15, v[76:79] offset:5120
    v_and_b32 v15, 15, v1
    v_lshrrev_b32 v16, 4, v1
    v_and_b32 v18, 1, v15
    v_mul_u32_u24 v19, 4162, v18
    v_lshlrev_b32 v15, 1, v15
    v_sub_u32 v19, v19, v15
    v_lshl_add_u32 v19, v16, 4, v19
    s_mul_i32 s44, s41, 8320
    s_lshl_b32 s45, s42, 8
    s_sub_u32 s44, s44, s45
    s_add_u32 s44, s44, 65408
    v_add_u32 v240, s44, v19
    v_subrev_u32 v241, 1024, v240
    v_subrev_u32 v242, 2048, v240
    v_subrev_u32 v243, 3072, v240
    v_lshlrev_b32 v15, 4, v15
    v_lshl_add_u32 v15, v16, 4, v15
    s_mul_i32 s44, s41, 4608
    s_xor_b32 s45, s42, 1
    s_lshl_b32 s45, s45, 8
    s_add_u32 s44, s44, s45
    s_add_u32 s44, s44, 32
    v_add_u32 v244, s44, v15
    s_waitcnt lgkmcnt(0)
    s_barrier
    ds_read_b128 v[144:147], v244 offset:192
    ds_read2_b32 v[80:81], v240 offset0:176 offset1:177
    ds_read2_b32 v[82:83], v240 offset0:178 offset1:179
    ds_read_b128 v[148:151], v244 offset:704
    ds_read2_b32 v[84:85], v240 offset0:48 offset1:49
    ds_read2_b32 v[86:87], v240 offset0:50 offset1:51
    ds_read_b128 v[152:155], v244 offset:1216
    ds_read2_b32 v[88:89], v241 offset0:176 offset1:177
    ds_read2_b32 v[90:91], v241 offset0:178 offset1:179
    ds_read_b128 v[156:159], v244 offset:1728
    ds_read2_b32 v[92:93], v241 offset0:48 offset1:49
    ds_read2_b32 v[94:95], v241 offset0:50 offset1:51
    ds_read_b128 v[160:163], v244 offset:2240
    ds_read2_b32 v[96:97], v242 offset0:176 offset1:177
    ds_read2_b32 v[98:99], v242 offset0:178 offset1:179
    ds_read_b128 v[164:167], v244 offset:2752
    ds_read2_b32 v[100:101], v242 offset0:48 offset1:49
    ds_read2_b32 v[102:103], v242 offset0:50 offset1:51
    ds_read_b128 v[168:171], v244 offset:3264
    ds_read2_b32 v[104:105], v243 offset0:176 offset1:177
    ds_read2_b32 v[106:107], v243 offset0:178 offset1:179
    ds_read_b128 v[172:175], v244 offset:3776
    ds_read2_b32 v[108:109], v243 offset0:48 offset1:49
    ds_read2_b32 v[110:111], v243 offset0:50 offset1:51
    s_waitcnt lgkmcnt(0)
    v_mfma_f32_16x16x32_bf16 v[208:211], v[80:83], v[144:147], 0
    ds_read_b128 v[176:179], v244 offset:128
    v_mfma_f32_16x16x32_bf16 v[212:215], v[80:83], v[148:151], 0
    ds_read2_b32 v[112:113], v240 offset0:160 offset1:161
    v_mfma_f32_16x16x32_bf16 v[216:219], v[80:83], v[152:155], 0
    ds_read2_b32 v[114:115], v240 offset0:162 offset1:163
    v_mfma_f32_16x16x32_bf16 v[220:223], v[80:83], v[156:159], 0
    ds_read_b128 v[180:183], v244 offset:640
    v_mfma_f32_16x16x32_bf16 v[224:227], v[80:83], v[160:163], 0
    ds_read2_b32 v[116:117], v240 offset0:32 offset1:33
    v_mfma_f32_16x16x32_bf16 v[228:231], v[80:83], v[164:167], 0
    ds_read2_b32 v[118:119], v240 offset0:34 offset1:35
    v_mfma_f32_16x16x32_bf16 v[232:235], v[80:83], v[168:171], 0
    ds_read_b128 v[184:187], v244 offset:1152
    v_mfma_f32_16x16x32_bf16 v[236:239], v[80:83], v[172:175], 0
    ds_read2_b32 v[120:121], v241 offset0:160 offset1:161
    v_mfma_f32_16x16x32_bf16 v[212:215], v[84:87], v[144:147], v[212:215]
    ds_read2_b32 v[122:123], v241 offset0:162 offset1:163
    v_mfma_f32_16x16x32_bf16 v[216:219], v[84:87], v[148:151], v[216:219]
    ds_read_b128 v[188:191], v244 offset:1664
    v_mfma_f32_16x16x32_bf16 v[220:223], v[84:87], v[152:155], v[220:223]
    ds_read2_b32 v[124:125], v241 offset0:32 offset1:33
    v_mfma_f32_16x16x32_bf16 v[224:227], v[84:87], v[156:159], v[224:227]
    ds_read2_b32 v[126:127], v241 offset0:34 offset1:35
    v_mfma_f32_16x16x32_bf16 v[228:231], v[84:87], v[160:163], v[228:231]
    ds_read_b128 v[192:195], v244 offset:2176
    v_mfma_f32_16x16x32_bf16 v[232:235], v[84:87], v[164:167], v[232:235]
    ds_read2_b32 v[128:129], v242 offset0:160 offset1:161
    v_mfma_f32_16x16x32_bf16 v[236:239], v[84:87], v[168:171], v[236:239]
    ds_read2_b32 v[130:131], v242 offset0:162 offset1:163
    v_mfma_f32_16x16x32_bf16 v[216:219], v[88:91], v[144:147], v[216:219]
    ds_read_b128 v[196:199], v244 offset:2688
    v_mfma_f32_16x16x32_bf16 v[220:223], v[88:91], v[148:151], v[220:223]
    ds_read2_b32 v[132:133], v242 offset0:32 offset1:33
    v_mfma_f32_16x16x32_bf16 v[224:227], v[88:91], v[152:155], v[224:227]
    ds_read2_b32 v[134:135], v242 offset0:34 offset1:35
    v_mfma_f32_16x16x32_bf16 v[228:231], v[88:91], v[156:159], v[228:231]
    ds_read_b128 v[200:203], v244 offset:3200
    v_mfma_f32_16x16x32_bf16 v[232:235], v[88:91], v[160:163], v[232:235]
    ds_read2_b32 v[136:137], v243 offset0:160 offset1:161
    v_mfma_f32_16x16x32_bf16 v[236:239], v[88:91], v[164:167], v[236:239]
    ds_read2_b32 v[138:139], v243 offset0:162 offset1:163
    v_mfma_f32_16x16x32_bf16 v[220:223], v[92:95], v[144:147], v[220:223]
    ds_read_b128 v[204:207], v244 offset:3712
    v_mfma_f32_16x16x32_bf16 v[224:227], v[92:95], v[148:151], v[224:227]
    ds_read2_b32 v[140:141], v243 offset0:32 offset1:33
    v_mfma_f32_16x16x32_bf16 v[228:231], v[92:95], v[152:155], v[228:231]
    ds_read2_b32 v[142:143], v243 offset0:34 offset1:35
    v_mfma_f32_16x16x32_bf16 v[232:235], v[92:95], v[156:159], v[232:235]
    v_mfma_f32_16x16x32_bf16 v[236:239], v[92:95], v[160:163], v[236:239]
    v_mfma_f32_16x16x32_bf16 v[224:227], v[96:99], v[144:147], v[224:227]
    v_mfma_f32_16x16x32_bf16 v[228:231], v[96:99], v[148:151], v[228:231]
    v_mfma_f32_16x16x32_bf16 v[232:235], v[96:99], v[152:155], v[232:235]
    v_mfma_f32_16x16x32_bf16 v[236:239], v[96:99], v[156:159], v[236:239]
    v_mfma_f32_16x16x32_bf16 v[228:231], v[100:103], v[144:147], v[228:231]
    v_mfma_f32_16x16x32_bf16 v[232:235], v[100:103], v[148:151], v[232:235]
    v_mfma_f32_16x16x32_bf16 v[236:239], v[100:103], v[152:155], v[236:239]
    v_mfma_f32_16x16x32_bf16 v[232:235], v[104:107], v[144:147], v[232:235]
    v_mfma_f32_16x16x32_bf16 v[236:239], v[104:107], v[148:151], v[236:239]
    v_mfma_f32_16x16x32_bf16 v[236:239], v[108:111], v[144:147], v[236:239]
    s_waitcnt lgkmcnt(0)
    v_mfma_f32_16x16x32_bf16 v[208:211], v[112:115], v[176:179], v[208:211]
    ds_read_b128 v[144:147], v244 offset:64
    v_mfma_f32_16x16x32_bf16 v[212:215], v[112:115], v[180:183], v[212:215]
    ds_read2_b32 v[80:81], v240 offset0:144 offset1:145
    v_mfma_f32_16x16x32_bf16 v[216:219], v[112:115], v[184:187], v[216:219]
    ds_read2_b32 v[82:83], v240 offset0:146 offset1:147
    v_mfma_f32_16x16x32_bf16 v[220:223], v[112:115], v[188:191], v[220:223]
    ds_read_b128 v[148:151], v244 offset:576
    v_mfma_f32_16x16x32_bf16 v[224:227], v[112:115], v[192:195], v[224:227]
    ds_read2_b32 v[84:85], v240 offset0:16 offset1:17
    v_mfma_f32_16x16x32_bf16 v[228:231], v[112:115], v[196:199], v[228:231]
    ds_read2_b32 v[86:87], v240 offset0:18 offset1:19
    v_mfma_f32_16x16x32_bf16 v[232:235], v[112:115], v[200:203], v[232:235]
    ds_read_b128 v[152:155], v244 offset:1088
    v_mfma_f32_16x16x32_bf16 v[236:239], v[112:115], v[204:207], v[236:239]
    ds_read2_b32 v[88:89], v241 offset0:144 offset1:145
    v_mfma_f32_16x16x32_bf16 v[212:215], v[116:119], v[176:179], v[212:215]
    ds_read2_b32 v[90:91], v241 offset0:146 offset1:147
    v_mfma_f32_16x16x32_bf16 v[216:219], v[116:119], v[180:183], v[216:219]
    ds_read_b128 v[156:159], v244 offset:1600
    v_mfma_f32_16x16x32_bf16 v[220:223], v[116:119], v[184:187], v[220:223]
    ds_read2_b32 v[92:93], v241 offset0:16 offset1:17
    v_mfma_f32_16x16x32_bf16 v[224:227], v[116:119], v[188:191], v[224:227]
    ds_read2_b32 v[94:95], v241 offset0:18 offset1:19
    v_mfma_f32_16x16x32_bf16 v[228:231], v[116:119], v[192:195], v[228:231]
    ds_read_b128 v[160:163], v244 offset:2112
    v_mfma_f32_16x16x32_bf16 v[232:235], v[116:119], v[196:199], v[232:235]
    ds_read2_b32 v[96:97], v242 offset0:144 offset1:145
    v_mfma_f32_16x16x32_bf16 v[236:239], v[116:119], v[200:203], v[236:239]
    ds_read2_b32 v[98:99], v242 offset0:146 offset1:147
    v_mfma_f32_16x16x32_bf16 v[216:219], v[120:123], v[176:179], v[216:219]
    ds_read_b128 v[164:167], v244 offset:2624
    v_mfma_f32_16x16x32_bf16 v[220:223], v[120:123], v[180:183], v[220:223]
    ds_read2_b32 v[100:101], v242 offset0:16 offset1:17
    v_mfma_f32_16x16x32_bf16 v[224:227], v[120:123], v[184:187], v[224:227]
    ds_read2_b32 v[102:103], v242 offset0:18 offset1:19
    v_mfma_f32_16x16x32_bf16 v[228:231], v[120:123], v[188:191], v[228:231]
    ds_read_b128 v[168:171], v244 offset:3136
    v_mfma_f32_16x16x32_bf16 v[232:235], v[120:123], v[192:195], v[232:235]
    ds_read2_b32 v[104:105], v243 offset0:144 offset1:145
    v_mfma_f32_16x16x32_bf16 v[236:239], v[120:123], v[196:199], v[236:239]
    ds_read2_b32 v[106:107], v243 offset0:146 offset1:147
    v_mfma_f32_16x16x32_bf16 v[220:223], v[124:127], v[176:179], v[220:223]
    ds_read_b128 v[172:175], v244 offset:3648
    v_mfma_f32_16x16x32_bf16 v[224:227], v[124:127], v[180:183], v[224:227]
    ds_read2_b32 v[108:109], v243 offset0:16 offset1:17
    v_mfma_f32_16x16x32_bf16 v[228:231], v[124:127], v[184:187], v[228:231]
    ds_read2_b32 v[110:111], v243 offset0:18 offset1:19
    v_mfma_f32_16x16x32_bf16 v[232:235], v[124:127], v[188:191], v[232:235]
    v_mfma_f32_16x16x32_bf16 v[236:239], v[124:127], v[192:195], v[236:239]
    v_mfma_f32_16x16x32_bf16 v[224:227], v[128:131], v[176:179], v[224:227]
    v_mfma_f32_16x16x32_bf16 v[228:231], v[128:131], v[180:183], v[228:231]
    v_mfma_f32_16x16x32_bf16 v[232:235], v[128:131], v[184:187], v[232:235]
    v_mfma_f32_16x16x32_bf16 v[236:239], v[128:131], v[188:191], v[236:239]
    v_mfma_f32_16x16x32_bf16 v[228:231], v[132:135], v[176:179], v[228:231]
    v_mfma_f32_16x16x32_bf16 v[232:235], v[132:135], v[180:183], v[232:235]
    v_mfma_f32_16x16x32_bf16 v[236:239], v[132:135], v[184:187], v[236:239]
    v_mfma_f32_16x16x32_bf16 v[232:235], v[136:139], v[176:179], v[232:235]
    v_mfma_f32_16x16x32_bf16 v[236:239], v[136:139], v[180:183], v[236:239]
    v_mfma_f32_16x16x32_bf16 v[236:239], v[140:143], v[176:179], v[236:239]
    s_waitcnt lgkmcnt(0)
    v_mfma_f32_16x16x32_bf16 v[208:211], v[80:83], v[144:147], v[208:211]
    ds_read_b128 v[176:179], v244 offset:0
    v_mfma_f32_16x16x32_bf16 v[212:215], v[80:83], v[148:151], v[212:215]
    ds_read2_b32 v[112:113], v240 offset0:128 offset1:129
    v_mfma_f32_16x16x32_bf16 v[216:219], v[80:83], v[152:155], v[216:219]
    ds_read2_b32 v[114:115], v240 offset0:130 offset1:131
    v_mfma_f32_16x16x32_bf16 v[220:223], v[80:83], v[156:159], v[220:223]
    ds_read_b128 v[180:183], v244 offset:512
    v_mfma_f32_16x16x32_bf16 v[224:227], v[80:83], v[160:163], v[224:227]
    ds_read2_b32 v[116:117], v240 offset0:0 offset1:1
    v_mfma_f32_16x16x32_bf16 v[228:231], v[80:83], v[164:167], v[228:231]
    ds_read2_b32 v[118:119], v240 offset0:2 offset1:3
    v_mfma_f32_16x16x32_bf16 v[232:235], v[80:83], v[168:171], v[232:235]
    ds_read_b128 v[184:187], v244 offset:1024
    v_mfma_f32_16x16x32_bf16 v[236:239], v[80:83], v[172:175], v[236:239]
    ds_read2_b32 v[120:121], v241 offset0:128 offset1:129
    v_mfma_f32_16x16x32_bf16 v[212:215], v[84:87], v[144:147], v[212:215]
    ds_read2_b32 v[122:123], v241 offset0:130 offset1:131
    v_mfma_f32_16x16x32_bf16 v[216:219], v[84:87], v[148:151], v[216:219]
    ds_read_b128 v[188:191], v244 offset:1536
    v_mfma_f32_16x16x32_bf16 v[220:223], v[84:87], v[152:155], v[220:223]
    ds_read2_b32 v[124:125], v241 offset0:0 offset1:1
    v_mfma_f32_16x16x32_bf16 v[224:227], v[84:87], v[156:159], v[224:227]
    ds_read2_b32 v[126:127], v241 offset0:2 offset1:3
    v_mfma_f32_16x16x32_bf16 v[228:231], v[84:87], v[160:163], v[228:231]
    ds_read_b128 v[192:195], v244 offset:2048
    v_mfma_f32_16x16x32_bf16 v[232:235], v[84:87], v[164:167], v[232:235]
    ds_read2_b32 v[128:129], v242 offset0:128 offset1:129
    v_mfma_f32_16x16x32_bf16 v[236:239], v[84:87], v[168:171], v[236:239]
    ds_read2_b32 v[130:131], v242 offset0:130 offset1:131
    v_mfma_f32_16x16x32_bf16 v[216:219], v[88:91], v[144:147], v[216:219]
    ds_read_b128 v[196:199], v244 offset:2560
    v_mfma_f32_16x16x32_bf16 v[220:223], v[88:91], v[148:151], v[220:223]
    ds_read2_b32 v[132:133], v242 offset0:0 offset1:1
    v_mfma_f32_16x16x32_bf16 v[224:227], v[88:91], v[152:155], v[224:227]
    ds_read2_b32 v[134:135], v242 offset0:2 offset1:3
    v_mfma_f32_16x16x32_bf16 v[228:231], v[88:91], v[156:159], v[228:231]
    ds_read_b128 v[200:203], v244 offset:3072
    v_mfma_f32_16x16x32_bf16 v[232:235], v[88:91], v[160:163], v[232:235]
    ds_read2_b32 v[136:137], v243 offset0:128 offset1:129
    v_mfma_f32_16x16x32_bf16 v[236:239], v[88:91], v[164:167], v[236:239]
    ds_read2_b32 v[138:139], v243 offset0:130 offset1:131
    v_mfma_f32_16x16x32_bf16 v[220:223], v[92:95], v[144:147], v[220:223]
    ds_read_b128 v[204:207], v244 offset:3584
    v_mfma_f32_16x16x32_bf16 v[224:227], v[92:95], v[148:151], v[224:227]
    ds_read2_b32 v[140:141], v243 offset0:0 offset1:1
    v_mfma_f32_16x16x32_bf16 v[228:231], v[92:95], v[152:155], v[228:231]
    ds_read2_b32 v[142:143], v243 offset0:2 offset1:3
    v_mfma_f32_16x16x32_bf16 v[232:235], v[92:95], v[156:159], v[232:235]
    v_mfma_f32_16x16x32_bf16 v[236:239], v[92:95], v[160:163], v[236:239]
    v_mfma_f32_16x16x32_bf16 v[224:227], v[96:99], v[144:147], v[224:227]
    v_mfma_f32_16x16x32_bf16 v[228:231], v[96:99], v[148:151], v[228:231]
    v_mfma_f32_16x16x32_bf16 v[232:235], v[96:99], v[152:155], v[232:235]
    v_mfma_f32_16x16x32_bf16 v[236:239], v[96:99], v[156:159], v[236:239]
    v_mfma_f32_16x16x32_bf16 v[228:231], v[100:103], v[144:147], v[228:231]
    v_mfma_f32_16x16x32_bf16 v[232:235], v[100:103], v[148:151], v[232:235]
    v_mfma_f32_16x16x32_bf16 v[236:239], v[100:103], v[152:155], v[236:239]
    v_mfma_f32_16x16x32_bf16 v[232:235], v[104:107], v[144:147], v[232:235]
    v_mfma_f32_16x16x32_bf16 v[236:239], v[104:107], v[148:151], v[236:239]
    v_mfma_f32_16x16x32_bf16 v[236:239], v[108:111], v[144:147], v[236:239]
    s_waitcnt lgkmcnt(0)
    v_mfma_f32_16x16x32_bf16 v[208:211], v[112:115], v[176:179], v[208:211]
    v_mfma_f32_16x16x32_bf16 v[212:215], v[112:115], v[180:183], v[212:215]
    v_mfma_f32_16x16x32_bf16 v[216:219], v[112:115], v[184:187], v[216:219]
    v_mfma_f32_16x16x32_bf16 v[220:223], v[112:115], v[188:191], v[220:223]
    v_mfma_f32_16x16x32_bf16 v[224:227], v[112:115], v[192:195], v[224:227]
    v_mfma_f32_16x16x32_bf16 v[228:231], v[112:115], v[196:199], v[228:231]
    v_mfma_f32_16x16x32_bf16 v[232:235], v[112:115], v[200:203], v[232:235]
    v_mfma_f32_16x16x32_bf16 v[236:239], v[112:115], v[204:207], v[236:239]
    v_mfma_f32_16x16x32_bf16 v[212:215], v[116:119], v[176:179], v[212:215]
    v_mfma_f32_16x16x32_bf16 v[216:219], v[116:119], v[180:183], v[216:219]
    v_mfma_f32_16x16x32_bf16 v[220:223], v[116:119], v[184:187], v[220:223]
    v_mfma_f32_16x16x32_bf16 v[224:227], v[116:119], v[188:191], v[224:227]
    v_mfma_f32_16x16x32_bf16 v[228:231], v[116:119], v[192:195], v[228:231]
    v_mfma_f32_16x16x32_bf16 v[232:235], v[116:119], v[196:199], v[232:235]
    v_mfma_f32_16x16x32_bf16 v[236:239], v[116:119], v[200:203], v[236:239]
    v_mfma_f32_16x16x32_bf16 v[216:219], v[120:123], v[176:179], v[216:219]
    v_mfma_f32_16x16x32_bf16 v[220:223], v[120:123], v[180:183], v[220:223]
    v_mfma_f32_16x16x32_bf16 v[224:227], v[120:123], v[184:187], v[224:227]
    v_mfma_f32_16x16x32_bf16 v[228:231], v[120:123], v[188:191], v[228:231]
    v_mfma_f32_16x16x32_bf16 v[232:235], v[120:123], v[192:195], v[232:235]
    v_mfma_f32_16x16x32_bf16 v[236:239], v[120:123], v[196:199], v[236:239]
    v_mfma_f32_16x16x32_bf16 v[220:223], v[124:127], v[176:179], v[220:223]
    v_mfma_f32_16x16x32_bf16 v[224:227], v[124:127], v[180:183], v[224:227]
    v_mfma_f32_16x16x32_bf16 v[228:231], v[124:127], v[184:187], v[228:231]
    v_mfma_f32_16x16x32_bf16 v[232:235], v[124:127], v[188:191], v[232:235]
    v_mfma_f32_16x16x32_bf16 v[236:239], v[124:127], v[192:195], v[236:239]
    v_mfma_f32_16x16x32_bf16 v[224:227], v[128:131], v[176:179], v[224:227]
    v_mfma_f32_16x16x32_bf16 v[228:231], v[128:131], v[180:183], v[228:231]
    v_mfma_f32_16x16x32_bf16 v[232:235], v[128:131], v[184:187], v[232:235]
    v_mfma_f32_16x16x32_bf16 v[236:239], v[128:131], v[188:191], v[236:239]
    v_mfma_f32_16x16x32_bf16 v[228:231], v[132:135], v[176:179], v[228:231]
    v_mfma_f32_16x16x32_bf16 v[232:235], v[132:135], v[180:183], v[232:235]
    v_mfma_f32_16x16x32_bf16 v[236:239], v[132:135], v[184:187], v[236:239]
    v_mfma_f32_16x16x32_bf16 v[232:235], v[136:139], v[176:179], v[232:235]
    v_mfma_f32_16x16x32_bf16 v[236:239], v[136:139], v[180:183], v[236:239]
    v_mfma_f32_16x16x32_bf16 v[236:239], v[140:143], v[176:179], v[236:239]
    v_lshlrev_b32 v15, 4, v1
    s_lshl_b32 s44, s40, 13
    s_add_u32 s44, s44, 16384
    v_add_u32 v16, s44, v15
    s_nop 3
    ds_write_b128 v16, v[208:211] offset:0
    ds_write_b128 v16, v[212:215] offset:1024
    ds_write_b128 v16, v[216:219] offset:2048
    ds_write_b128 v16, v[220:223] offset:3072
    ds_write_b128 v16, v[224:227] offset:4096
    ds_write_b128 v16, v[228:231] offset:5120
    ds_write_b128 v16, v[232:235] offset:6144
    ds_write_b128 v16, v[236:239] offset:7168
    s_lshl_b32 s44, s40, 11
    s_add_u32 s45, s44, 16384
    v_add_u32 v16, s45, v15
    v_and_b32 v17, 15, v1
    v_lshrrev_b32 v18, 4, v1
    v_lshlrev_b32 v17, 5, v17
    v_lshl_add_u32 v17, v18, 3, v17
    v_lshlrev_b32 v19, 1, v17
    s_lshl_b32 s45, s40, 10
    v_add_u32 v17, s45, v17
    s_lshl_b32 s46, s2, 13
    s_add_u32 s46, s46, s44
    s_lshl_b32 s47, s43, 16
    s_and_b32 s48, s43, 0xffff0000
    s_waitcnt lgkmcnt(0)
    s_barrier
    s_add_u32 s32, s22, 8388608
    s_addc_u32 s33, s23, 0
    s_mov_b32 s34, 0x200000
    s_mov_b32 s35, 0x20000
    ds_read_b128 v[80:83], v16 offset:0
    ds_read_b128 v[84:87], v16 offset:8192
    ds_read_b128 v[88:91], v16 offset:16384
    ds_read_b128 v[92:95], v16 offset:24576
    ds_read_b64 v[120:121], v17 offset:512
    ds_read_b64 v[122:123], v17 offset:5120
    ds_read_b128 v[96:99], v16 offset:1024
    ds_read_b128 v[100:103], v16 offset:9216
    ds_read_b128 v[104:107], v16 offset:17408
    ds_read_b128 v[108:111], v16 offset:25600
    ds_read_b64 v[124:125], v17 offset:1024
    ds_read_b64 v[126:127], v17 offset:5632
    s_waitcnt lgkmcnt(6)
    v_add_f32 v80, v80, v84
    v_add_f32 v81, v81, v85
    v_add_f32 v82, v82, v86
    v_add_f32 v83, v83, v87
    v_lshlrev_b32 v20, 16, v120
    v_fma_f32 v80, v20, s47, v80
    v_and_b32 v20, 0xffff0000, v120
    v_fma_f32 v81, v20, s47, v81
    v_lshlrev_b32 v20, 16, v121
    v_fma_f32 v82, v20, s47, v82
    v_and_b32 v20, 0xffff0000, v121
    v_fma_f32 v83, v20, s47, v83
    v_add_f32 v88, v88, v92
    v_add_f32 v89, v89, v93
    v_add_f32 v90, v90, v94
    v_add_f32 v91, v91, v95
    v_lshlrev_b32 v20, 16, v122
    v_fma_f32 v88, v20, s48, v88
    v_and_b32 v20, 0xffff0000, v122
    v_fma_f32 v89, v20, s48, v89
    v_lshlrev_b32 v20, 16, v123
    v_fma_f32 v90, v20, s48, v90
    v_and_b32 v20, 0xffff0000, v123
    v_fma_f32 v91, v20, s48, v91
    v_cvt_pk_bf16_f32 v128, v80, v88
    v_cvt_pk_bf16_f32 v129, v81, v89
    v_cvt_pk_bf16_f32 v130, v82, v90
    v_cvt_pk_bf16_f32 v131, v83, v91
    s_add_u32 s45, s46, 0
    buffer_store_dwordx4 v[128:131], v19, s[32:35], s45 offen sc1
    s_waitcnt lgkmcnt(0)
    v_add_f32 v96, v96, v100
    v_add_f32 v97, v97, v101
    v_add_f32 v98, v98, v102
    v_add_f32 v99, v99, v103
    v_lshlrev_b32 v20, 16, v124
    v_fma_f32 v96, v20, s47, v96
    v_and_b32 v20, 0xffff0000, v124
    v_fma_f32 v97, v20, s47, v97
    v_lshlrev_b32 v20, 16, v125
    v_fma_f32 v98, v20, s47, v98
    v_and_b32 v20, 0xffff0000, v125
    v_fma_f32 v99, v20, s47, v99
    v_add_f32 v104, v104, v108
    v_add_f32 v105, v105, v109
    v_add_f32 v106, v106, v110
    v_add_f32 v107, v107, v111
    v_lshlrev_b32 v20, 16, v126
    v_fma_f32 v104, v20, s48, v104
    v_and_b32 v20, 0xffff0000, v126
    v_fma_f32 v105, v20, s48, v105
    v_lshlrev_b32 v20, 16, v127
    v_fma_f32 v106, v20, s48, v106
    v_and_b32 v20, 0xffff0000, v127
    v_fma_f32 v107, v20, s48, v107
    v_cvt_pk_bf16_f32 v132, v96, v104
    v_cvt_pk_bf16_f32 v133, v97, v105
    v_cvt_pk_bf16_f32 v134, v98, v106
    v_cvt_pk_bf16_f32 v135, v99, v107
    s_add_u32 s45, s46, 1024
    buffer_store_dwordx4 v[132:135], v19, s[32:35], s45 offen sc1
    s_waitcnt vmcnt(0)
    s_lshl_b32 s58, s2, 2
    s_add_u32 s58, s58, s40
    s_mul_i32 s58, s58, 4
    s_add_u32 s58, s58, 720896
    v_mov_b32 v254, s62
    v_mov_b32 v255, 0
    s_mov_b64 exec, 1
    buffer_store_dword v254, v255, s[36:39], s58 offen sc1
    s_mov_b64 exec, -1
    s_or_b32 s44, s2, s40
    s_cmp_lg_u32 s44, 0
    s_cbranch_scc1 EPO_26
    s_mov_b32 s45, 2000
    v_mul_u32_u24 v12, 4, v1
EPT_27:
    s_mov_b32 s46, 196608
    buffer_load_dword v16, v12, s[36:39], s46 offen sc1
    s_mov_b32 s46, 196864
    buffer_load_dword v17, v12, s[36:39], s46 offen sc1
    s_mov_b32 s46, 197120
    buffer_load_dword v18, v12, s[36:39], s46 offen sc1
    s_mov_b32 s46, 197376
    buffer_load_dword v19, v12, s[36:39], s46 offen sc1
    s_mov_b32 s46, 197632
    buffer_load_dword v20, v12, s[36:39], s46 offen sc1
    s_mov_b32 s46, 197888
    buffer_load_dword v21, v12, s[36:39], s46 offen sc1
    s_mov_b32 s46, 198144
    buffer_load_dword v22, v12, s[36:39], s46 offen sc1
    s_mov_b32 s46, 198400
    buffer_load_dword v23, v12, s[36:39], s46 offen sc1
    s_mov_b32 s46, 198656
    buffer_load_dword v24, v12, s[36:39], s46 offen sc1
    s_mov_b32 s46, 198912
    buffer_load_dword v25, v12, s[36:39], s46 offen sc1
    s_mov_b32 s46, 199168
    buffer_load_dword v26, v12, s[36:39], s46 offen sc1
    s_mov_b32 s46, 199424
    buffer_load_dword v27, v12, s[36:39], s46 offen sc1
    s_mov_b32 s46, 199680
    buffer_load_dword v28, v12, s[36:39], s46 offen sc1
    s_mov_b32 s46, 199936
    buffer_load_dword v29, v12, s[36:39], s46 offen sc1
    s_mov_b32 s46, 200192
    buffer_load_dword v30, v12, s[36:39], s46 offen sc1
    s_mov_b32 s46, 200448
    buffer_load_dword v31, v12, s[36:39], s46 offen sc1
    s_mov_b32 s46, 458752
    buffer_load_dword v32, v12, s[36:39], s46 offen sc1
    s_mov_b32 s46, 459008
    buffer_load_dword v33, v12, s[36:39], s46 offen sc1
    s_mov_b32 s46, 459264
    buffer_load_dword v34, v12, s[36:39], s46 offen sc1
    s_mov_b32 s46, 459520
    buffer_load_dword v35, v12, s[36:39], s46 offen sc1
    s_mov_b32 s46, 459776
    buffer_load_dword v36, v12, s[36:39], s46 offen sc1
    s_mov_b32 s46, 460032
    buffer_load_dword v37, v12, s[36:39], s46 offen sc1
    s_mov_b32 s46, 460288
    buffer_load_dword v38, v12, s[36:39], s46 offen sc1
    s_mov_b32 s46, 460544
    buffer_load_dword v39, v12, s[36:39], s46 offen sc1
    s_mov_b32 s46, 460800
    buffer_load_dword v40, v12, s[36:39], s46 offen sc1
    s_mov_b32 s46, 461056
    buffer_load_dword v41, v12, s[36:39], s46 offen sc1
    s_mov_b32 s46, 461312
    buffer_load_dword v42, v12, s[36:39], s46 offen sc1
    s_mov_b32 s46, 461568
    buffer_load_dword v43, v12, s[36:39], s46 offen sc1
    s_mov_b32 s46, 461824
    buffer_load_dword v44, v12, s[36:39], s46 offen sc1
    s_mov_b32 s46, 462080
    buffer_load_dword v45, v12, s[36:39], s46 offen sc1
    s_mov_b32 s46, 462336
    buffer_load_dword v46, v12, s[36:39], s46 offen sc1
    s_mov_b32 s46, 462592
    buffer_load_dword v47, v12, s[36:39], s46 offen sc1
    s_waitcnt vmcnt(0)
    v_xor_b32 v15, s62, v16
    v_xor_b32 v17, s62, v17
    v_or_b32 v15, v15, v17
    v_xor_b32 v18, s62, v18
    v_or_b32 v15, v15, v18
    v_xor_b32 v19, s62, v19
    v_or_b32 v15, v15, v19
    v_xor_b32 v20, s62, v20
    v_or_b32 v15, v15, v20
    v_xor_b32 v21, s62, v21
    v_or_b32 v15, v15, v21
    v_xor_b32 v22, s62, v22
    v_or_b32 v15, v15, v22
    v_xor_b32 v23, s62, v23
    v_or_b32 v15, v15, v23
    v_xor_b32 v24, s62, v24
    v_or_b32 v15, v15, v24
    v_xor_b32 v25, s62, v25
    v_or_b32 v15, v15, v25
    v_xor_b32 v26, s62, v26
    v_or_b32 v15, v15, v26
    v_xor_b32 v27, s62, v27
    v_or_b32 v15, v15, v27
    v_xor_b32 v28, s62, v28
    v_or_b32 v15, v15, v28
    v_xor_b32 v29, s62, v29
    v_or_b32 v15, v15, v29
    v_xor_b32 v30, s62, v30
    v_or_b32 v15, v15, v30
    v_xor_b32 v31, s62, v31
    v_or_b32 v15, v15, v31
    v_xor_b32 v32, s62, v32
    v_or_b32 v15, v15, v32
    v_xor_b32 v33, s62, v33
    v_or_b32 v15, v15, v33
    v_xor_b32 v34, s62, v34
    v_or_b32 v15, v15, v34
    v_xor_b32 v35, s62, v35
    v_or_b32 v15, v15, v35
    v_xor_b32 v36, s62, v36
    v_or_b32 v15, v15, v36
    v_xor_b32 v37, s62, v37
    v_or_b32 v15, v15, v37
    v_xor_b32 v38, s62, v38
    v_or_b32 v15, v15, v38
    v_xor_b32 v39, s62, v39
    v_or_b32 v15, v15, v39
    v_xor_b32 v40, s62, v40
    v_or_b32 v15, v15, v40
    v_xor_b32 v41, s62, v41
    v_or_b32 v15, v15, v41
    v_xor_b32 v42, s62, v42
    v_or_b32 v15, v15, v42
    v_xor_b32 v43, s62, v43
    v_or_b32 v15, v15, v43
    v_xor_b32 v44, s62, v44
    v_or_b32 v15, v15, v44
    v_xor_b32 v45, s62, v45
    v_or_b32 v15, v15, v45
    v_xor_b32 v46, s62, v46
    v_or_b32 v15, v15, v46
    v_xor_b32 v47, s62, v47
    v_or_b32 v15, v15, v47
    v_cmp_ne_u32 vcc, 0, v15
    s_cbranch_vccz EPK_28
    s_sub_u32 s45, s45, 1
    s_cmp_lg_u32 s45, 0
    s_cbranch_scc1 EPT_27
EPK_28:
    v_mov_b32 v12, s62
    v_mov_b32 v13, 0
    s_mov_b64 exec, 1
    buffer_store_dword v12, v13, s[36:39], 0 offen sc1
    s_mov_b64 exec, -1
EPO_26:
END_ALL:
    s_endpgm

.section .rodata,"a"
.p2align 6
.amdhsa_kernel gated_mix__ssm_conv_s4__dense_activation_relu__prompt_kernel
  .amdhsa_next_free_vgpr 256
  .amdhsa_next_free_sgpr 96
  .amdhsa_accum_offset 256
  .amdhsa_group_segment_fixed_size 0
  .amdhsa_kernarg_size 128
  .amdhsa_user_sgpr_count 2
  .amdhsa_user_sgpr_kernarg_segment_ptr 1
  .amdhsa_system_sgpr_workgroup_id_x 1
.end_amdhsa_kernel
```
